```python
import torch

def _softmax(x, axis=-1):
    return torch.softmax(x, dim=axis)
def _gelu(x):
    return torch.nn.functional.gelu(x, approximate="tanh")
def _silu(x):
    return torch.nn.functional.silu(x)
def _sigmoid(x):
    return torch.sigmoid(x)
def _layernorm(x, axis=-1, eps=1e-5):
    m = x.mean(dim=axis, keepdim=True)
    v = x.var(dim=axis, keepdim=True, unbiased=False)
    return (x - m) / torch.sqrt(v + eps)
def _scatter_add(tgt, idx, src, axis=0):
    return tgt.clone().index_add_(axis, idx, src)
def _segment_sum(src, seg, n):
    out = torch.zeros((n,) + src.shape[1:], dtype=src.dtype)
    return out.index_add_(0, seg, src)
def _pad(x, pw):
    flat = tuple(v for pair in reversed(pw) for v in pair)
    return torch.nn.functional.pad(x, flat)

kernel_name = 'standalone__mixer_channel_mlp__prompt'

def setup_inputs():

    _w = (lambda a: (lambda t: t.to(torch.bfloat16) if t.is_floating_point() else t)(torch.as_tensor(a)))
    B, S, D, F = 1, 2048, 512, 1792
    return {
        "x": _w((lambda *s: torch.randn(*s, dtype=torch.bfloat16) * 0.05)(B, S, D)),
        "w1": _w((lambda *s: torch.randn(*s, dtype=torch.bfloat16) * 0.8)(D, F) * (D ** -0.5)),
        "b1": _w((lambda *s: torch.randn(*s, dtype=torch.bfloat16) * 0.4)(F)),
        "w2": _w((lambda *s: torch.randn(*s, dtype=torch.bfloat16) * 0.05)(F, D) * (F ** -0.5)),
        "b2": _w((lambda *s: torch.randn(*s, dtype=torch.bfloat16) * 0.05)(D)),
    }

def reference(x, w1, b1, w2, b2):
    y = _layernorm(x, axis=-1)
    h = _gelu(torch.einsum("bsd,df->bsf", y, w1) + b1)
    return torch.einsum("bsf,fd->bsd", h, w2) + b2
```

```asm
; @launch grid=(256,1,1) block=(512,1,1) lds=163840
.amdgcn_target "amdgcn-amd-amdhsa--gfx950"
.text
.globl standalone__mixer_channel_mlp__prompt_kernel
.p2align 8
.type standalone__mixer_channel_mlp__prompt_kernel,@function
standalone__mixer_channel_mlp__prompt_kernel:
    s_load_dwordx16 s[4:19], s[0:1], 0
    s_cmp_ge_u32 s2, 256
    s_cbranch_scc1 L_end
    v_lshrrev_b32 v2, 6, v0
    v_and_b32 v1, 63, v0
    v_readfirstlane_b32 s20, v2
    s_and_b32 s21, s2, 7
    s_lshr_b32 s22, s2, 3
    s_cmp_lg_u32 s20, 7
    s_cbranch_scc1 L_nocpf
    s_getpc_b64 s[66:67]
L_pc:
    s_lshl_b32 s59, s22, 7
    v_lshl_add_u32 v2, v1, 12, s59
    v_min_u32 v2, L_end-L_pc, v2
    s_mov_b64 exec, 0x3f
    global_load_dword v254, v2, s[66:67]
    s_mov_b64 exec, -1
L_nocpf:
    s_lshr_b32 s59, s21, 1
    s_and_b32 s60, s21, 1
    s_and_b32 s61, s22, 3
    s_lshr_b32 s62, s22, 2
    s_lshl2_add_u32 s23, s59, s61
    s_mul_i32 s56, s60, 7
    s_add_u32 s56, s56, s62
    s_cmp_ge_u32 s22, 28
    s_cbranch_scc1 L_helper
    s_cmp_ge_u32 s20, 4
    s_cbranch_scc1 L_p1
    s_add_u32 s90, s61, s62
    s_lshl_b32 s90, s90, 1
    v_lshrrev_b32 v29, 3, v1
    v_and_b32 v30, 7, v1
    v_lshrrev_b32 v31, 4, v1
    v_lshlrev_b32 v32, 2, v31
    v_and_b32 v32, 4, v32
    v_xor_b32 v33, v30, v32
    v_mul_u32_u24 v6, 3584, v29
    v_lshl_add_u32 v6, v33, 4, v6
    v_add_u32 v7, 27648, v6
    v_add_u32 v8, 55296, v6
    v_add_u32 v9, 82944, v6
    v_xor_b32 v32, v30, v31
    v_lshlrev_b32 v32, 4, v32
    v_lshl_add_u32 v2, v29, 10, v32
    v_xor_b32 v3, 64, v2
    v_add_u32 v4, 14336, v2
    v_add_u32 v3, 7168, v3
    v_add_u32 v5, 14336, v3
    s_lshl_b32 s64, s23, 17
    s_lshl_b32 s59, s20, 15
    s_add_u32 s64, s64, s59
    s_lshl_b32 s69, s56, 8
    s_mul_i32 s59, s20, 57344
    s_add_u32 s69, s69, s59
    s_add_u32 s65, s69, s59
    s_add_u32 s65, s65, 128
    s_lshl_b32 s66, s20, 12
    s_lshl_b32 s67, s20, 11
    s_mov_b32 s27, 0x00020000
    s_mov_b32 s31, 0x00020000
    s_mov_b32 s26, 2097152
    s_mov_b32 s30, 1835008
    s_waitcnt lgkmcnt(0)
    s_mov_b64 s[24:25], s[4:5]
    s_mov_b64 s[28:29], s[6:7]
    s_add_u32 m0, s67, 16384
    s_add_u32 s91, s90, 0
    s_and_b32 s91, s91, 7
    s_mul_i32 s94, s91, 229376
    s_add_u32 s94, s94, s69
    buffer_load_dwordx4 v6, s[28:31], s94 offen offset:0  lds
    buffer_load_dwordx4 v7, s[28:31], s94 offen offset:1024  lds
    s_add_u32 m0, s66, 0
    s_lshl_b32 s94, s91, 7
    s_add_u32 s94, s94, s64
    buffer_load_dwordx4 v2, s[24:27], s94 offen offset:0  lds
    buffer_load_dwordx4 v3, s[24:27], s94 offen offset:1024  lds
    buffer_load_dwordx4 v4, s[24:27], s94 offen offset:2048  lds
    buffer_load_dwordx4 v5, s[24:27], s94 offen offset:3072  lds
    s_add_u32 m0, s67, 40960
    s_add_u32 s91, s90, 1
    s_and_b32 s91, s91, 7
    s_mul_i32 s94, s91, 229376
    s_add_u32 s94, s94, s69
    buffer_load_dwordx4 v6, s[28:31], s94 offen offset:0  lds
    buffer_load_dwordx4 v7, s[28:31], s94 offen offset:1024  lds
    s_add_u32 m0, s66, 24576
    s_lshl_b32 s94, s91, 7
    s_add_u32 s94, s94, s64
    buffer_load_dwordx4 v2, s[24:27], s94 offen offset:0  lds
    buffer_load_dwordx4 v3, s[24:27], s94 offen offset:1024  lds
    buffer_load_dwordx4 v4, s[24:27], s94 offen offset:2048  lds
    buffer_load_dwordx4 v5, s[24:27], s94 offen offset:3072  lds
    s_and_b32 s59, s22, 3
    s_lshl2_add_u32 s57, s21, s59
    s_mov_b32 s58, 4
    s_lshr_b32 s58, s22, 2
    s_cmp_ge_u32 s58, 3
    s_addc_u32 s58, s58, 0
    s_mov_b64 s[32:33], s[10:11]
    s_mov_b32 s34, 1835008
    s_mov_b32 s35, 0x00020000
    s_mov_b64 s[40:41], s[14:15]
    s_mov_b32 s42, 2097152
    s_mov_b32 s43, 0x00020000
    s_mov_b64 s[52:53], s[12:13]
    s_mov_b32 s54, 1024
    s_mov_b32 s55, 0x00020000
    s_mov_b64 s[36:37], s[18:19]
    s_mov_b32 s38, 268435456
    s_mov_b32 s39, 0x00020000
    s_mov_b64 s[44:45], s[16:17]
    s_mov_b32 s46, 256
    s_mov_b32 s47, 0x00020000
    v_lshrrev_b32 v29, 3, v1
    v_and_b32 v30, 7, v1
    v_lshrrev_b32 v32, 2, v1
    v_and_b32 v32, 4, v32
    v_xor_b32 v32, v30, v32
    v_lshlrev_b32 v32, 4, v32
    v_lshl_add_u32 v10, v29, 10, v32
    v_add_u32 v11, 7168, v10
    s_lshr_b32 s59, s20, 1
    s_mul_i32 s100, s59, 917504
    s_lshl_b32 s59, s58, 7
    s_add_u32 s100, s100, s59
    s_and_b32 s60, s20, 1
    s_mul_i32 s61, s60, 507904
    s_add_u32 s101, s100, s61
    s_mul_i32 s61, s60, 409600
    s_add_u32 s100, s100, s61
    s_mul_i32 s3, s20, 6144
    s_lshl_b32 s99, s20, 13
    s_add_u32 s99, s99, 98304
    s_lshl2_add_u32 s88, s57, s20
    s_mul_i32 s88, s88, 128
    s_add_u32 s88, s88, 8388608
    s_add_u32 s88, s88, s18
    s_addc_u32 s89, s19, 0
    v_lshlrev_b32 v12, 4, v1
    v_mov_b32 v24, 0
    v_bfe_u32 v29, v1, 2, 2
    v_and_b32 v30, 3, v1
    v_lshlrev_b32 v30, 3, v30
    v_lshl_add_u32 v30, v29, 7, v30
    v_bfe_u32 v32, v1, 3, 1
    v_lshl_add_u32 v30, v32, 6, v30
    v_lshrrev_b32 v32, 5, v1
    v_lshl_add_u32 v33, v32, 9, v30
    v_bfe_u32 v34, v1, 4, 1
    v_lshl_add_u32 v33, v34, 5, v33
    s_lshr_b32 s59, s20, 1
    s_lshl_b32 s59, s59, 6
    v_xor_b32 v33, s59, v33
    v_xor_b32 v34, 64, v33
    v_add_u32 v13, s3, v33
    v_add_u32 v14, s3, v34
    v_add_u32 v15, 73728, v13
    v_add_u32 v16, 73728, v14
    v_add_u32 v17, s99, v33
    v_add_u32 v18, s99, v34
    s_lshl1_add_u32 s59, s57, s60
    s_mul_i32 s95, s59, 114688
    s_xor_b32 s61, s59, 1
    s_mul_i32 s96, s61, 114688
    s_mul_i32 s61, s20, 7168
    s_add_u32 s95, s95, s61
    s_add_u32 s96, s96, s61
    v_and_b32 v33, 31, v1
    v_lshlrev_b32 v36, 10, v33
    v_lshl_add_u32 v36, v32, 4, v36
    s_lshl_b32 s59, s59, 15
    s_lshr_b32 s61, s20, 1
    s_lshl1_add_u32 s61, s58, s61
    s_lshl_b32 s61, s61, 6
    s_add_u32 s59, s59, s61
    v_add_u32 v36, s59, v36
    v_lshlrev_b32 v32, 3, v32
    buffer_load_dwordx2 v[40:41], v32, s[52:55], s61 offen offset:0
    buffer_load_dwordx2 v[42:43], v32, s[52:55], s61 offen offset:16
    buffer_load_dwordx2 v[44:45], v32, s[52:55], s61 offen offset:32
    buffer_load_dwordx2 v[46:47], v32, s[52:55], s61 offen offset:48
    v_mul_u32_u24 v38, 144, v33
    v_add_u32 v38, v38, v32
    s_mul_i32 s59, s60, 4608
    s_lshr_b32 s61, s20, 1
    s_lshl_b32 s61, s61, 6
    s_add_u32 s59, s59, s61
    v_add_u32 v38, s59, v38
    v_lshrrev_b32 v29, 3, v1
    v_and_b32 v30, 7, v1
    v_lshlrev_b32 v30, 4, v30
    v_mul_u32_u24 v39, 144, v29
    v_add_u32 v39, v39, v30
    s_mul_i32 s59, s20, 2304
    v_add_u32 v39, s59, v39
    v_lshl_add_u32 v36, v29, 10, v30
    s_lshl2_add_u32 s59, s57, s20
    s_lshl_b32 s59, s59, 14
    s_lshl_b32 s61, s58, 7
    s_add_u32 s59, s59, s61
    v_add_u32 v36, s59, v36
    v_add_u32 v37, s99, v12
    s_xor_b32 s59, s20, 1
    s_lshl_b32 s59, s59, 13
    s_add_u32 s59, s59, 98304
    v_add_u32 v25, s59, v12
    s_xor_b32 s59, s20, 2
    s_lshl_b32 s59, s59, 13
    s_add_u32 s59, s59, 102400
    v_add_u32 v26, s59, v12
    s_xor_b32 s59, s20, 3
    s_lshl_b32 s59, s59, 13
    s_add_u32 s59, s59, 131072
    v_add_u32 v27, s59, v12
    s_add_u32 m0, s67, 65536
    s_add_u32 s91, s90, 2
    s_and_b32 s91, s91, 7
    s_mul_i32 s94, s91, 229376
    s_add_u32 s94, s94, s69
    buffer_load_dwordx4 v6, s[28:31], s94 offen offset:0  lds
    buffer_load_dwordx4 v7, s[28:31], s94 offen offset:1024  lds
    s_add_u32 m0, s66, 49152
    s_lshl_b32 s94, s91, 7
    s_add_u32 s94, s94, s64
    buffer_load_dwordx4 v2, s[24:27], s94 offen offset:0  lds
    buffer_load_dwordx4 v3, s[24:27], s94 offen offset:1024  lds
    s_waitcnt vmcnt(14)
    s_barrier
    buffer_load_dwordx4 v4, s[24:27], s94 offen offset:2048  lds
    buffer_load_dwordx4 v5, s[24:27], s94 offen offset:3072  lds
    s_add_u32 m0, s67, 90112
    s_add_u32 s91, s90, 3
    s_and_b32 s91, s91, 7
    s_mul_i32 s94, s91, 229376
    s_add_u32 s94, s94, s69
    buffer_load_dwordx4 v6, s[28:31], s94 offen offset:0  lds
    buffer_load_dwordx4 v7, s[28:31], s94 offen offset:1024  lds
    s_add_u32 m0, s66, 73728
    s_lshl_b32 s94, s91, 7
    s_add_u32 s94, s94, s64
    buffer_load_dwordx4 v2, s[24:27], s94 offen offset:0  lds
    buffer_load_dwordx4 v3, s[24:27], s94 offen offset:1024  lds
    s_waitcnt vmcnt(14)
    s_barrier
    buffer_load_dwordx4 v4, s[24:27], s94 offen offset:2048  lds
    buffer_load_dwordx4 v5, s[24:27], s94 offen offset:3072  lds
    s_add_u32 m0, s67, 16384
    s_add_u32 s91, s90, 4
    s_and_b32 s91, s91, 7
    s_mul_i32 s94, s91, 229376
    s_add_u32 s94, s94, s69
    buffer_load_dwordx4 v6, s[28:31], s94 offen offset:0  lds
    buffer_load_dwordx4 v7, s[28:31], s94 offen offset:1024  lds
    s_add_u32 m0, s66, 0
    s_lshl_b32 s94, s91, 7
    s_add_u32 s94, s94, s64
    buffer_load_dwordx4 v2, s[24:27], s94 offen offset:0  lds
    buffer_load_dwordx4 v3, s[24:27], s94 offen offset:1024  lds
    buffer_load_dwordx4 v4, s[24:27], s94 offen offset:2048  lds
    buffer_load_dwordx4 v5, s[24:27], s94 offen offset:3072  lds
    s_waitcnt vmcnt(12)
    s_barrier
    s_add_u32 m0, s67, 40960
    s_add_u32 s91, s90, 5
    s_and_b32 s91, s91, 7
    s_mul_i32 s94, s91, 229376
    s_add_u32 s94, s94, s69
    buffer_load_dwordx4 v6, s[28:31], s94 offen offset:0  lds
    v_lshlrev_b32 v64, 16, v40
    v_and_b32 v65, 0xffff0000, v40
    buffer_load_dwordx4 v7, s[28:31], s94 offen offset:1024  lds
    v_lshlrev_b32 v66, 16, v41
    v_and_b32 v67, 0xffff0000, v41
    v_lshlrev_b32 v68, 16, v42
    s_add_u32 m0, s66, 24576
    s_lshl_b32 s94, s91, 7
    s_add_u32 s94, s94, s64
    buffer_load_dwordx4 v2, s[24:27], s94 offen offset:0  lds
    v_and_b32 v69, 0xffff0000, v42
    v_lshlrev_b32 v70, 16, v43
    v_and_b32 v71, 0xffff0000, v43
    buffer_load_dwordx4 v3, s[24:27], s94 offen offset:1024  lds
    v_lshlrev_b32 v72, 16, v44
    v_and_b32 v73, 0xffff0000, v44
    v_lshlrev_b32 v74, 16, v45
    buffer_load_dwordx4 v4, s[24:27], s94 offen offset:2048  lds
    v_and_b32 v75, 0xffff0000, v45
    v_lshlrev_b32 v76, 16, v46
    v_and_b32 v77, 0xffff0000, v46
    buffer_load_dwordx4 v5, s[24:27], s94 offen offset:3072  lds
    v_lshlrev_b32 v78, 16, v47
    v_and_b32 v79, 0xffff0000, v47
    s_waitcnt vmcnt(12)
    s_barrier
    s_add_u32 m0, s67, 65536
    s_add_u32 s91, s90, 6
    s_and_b32 s91, s91, 7
    s_mul_i32 s94, s91, 229376
    s_add_u32 s94, s94, s69
    buffer_load_dwordx4 v6, s[28:31], s94 offen offset:0  lds
    buffer_load_dwordx4 v7, s[28:31], s94 offen offset:1024  lds
    s_add_u32 m0, s66, 49152
    s_lshl_b32 s94, s91, 7
    s_add_u32 s94, s94, s64
    buffer_load_dwordx4 v2, s[24:27], s94 offen offset:0  lds
    buffer_load_dwordx4 v3, s[24:27], s94 offen offset:1024  lds
    buffer_load_dwordx4 v4, s[24:27], s94 offen offset:2048  lds
    buffer_load_dwordx4 v5, s[24:27], s94 offen offset:3072  lds
    s_lshl2_add_u32 s86, s22, s20
    s_lshl_b32 s86, s86, 11
    v_lshlrev_b32 v28, 7, v1
    s_add_u32 s59, s21, 0
    s_and_b32 s59, s59, 7
    s_mul_i32 s59, s59, 229376
    s_add_u32 s59, s59, s86
    s_mov_b64 exec, 0xffff
    buffer_load_dword v200, v28, s[32:35], s59 offen
    s_mov_b64 exec, -1
    s_waitcnt vmcnt(13)
    s_barrier
    s_cmp_lg_u32 s20, 0
    s_cbranch_scc1 L_w01
    buffer_load_dwordx4 v[20:23], off, s[44:47], 0 sc1
L_w01:
    s_add_u32 m0, s67, 90112
    s_add_u32 s91, s90, 7
    s_and_b32 s91, s91, 7
    s_mul_i32 s94, s91, 229376
    s_add_u32 s94, s94, s69
    buffer_load_dwordx4 v6, s[28:31], s94 offen offset:0  lds
    buffer_load_dwordx4 v7, s[28:31], s94 offen offset:1024  lds
    s_add_u32 m0, s66, 73728
    s_lshl_b32 s94, s91, 7
    s_add_u32 s94, s94, s64
    buffer_load_dwordx4 v2, s[24:27], s94 offen offset:0  lds
    buffer_load_dwordx4 v3, s[24:27], s94 offen offset:1024  lds
    s_waitcnt vmcnt(11)
    s_barrier
    buffer_load_dwordx4 v4, s[24:27], s94 offen offset:2048  lds
    buffer_load_dwordx4 v5, s[24:27], s94 offen offset:3072  lds
    s_add_u32 m0, s66, 98304
    s_add_u32 s91, s90, 0
    s_and_b32 s91, s91, 7
    s_mul_i32 s94, s91, 229376
    s_add_u32 s94, s94, s65
    buffer_load_dwordx4 v6, s[28:31], s94 offen offset:0  lds
    buffer_load_dwordx4 v7, s[28:31], s94 offen offset:1024  lds
    buffer_load_dwordx4 v8, s[28:31], s94 offen offset:2048  lds
    buffer_load_dwordx4 v9, s[28:31], s94 offen offset:3072  lds
    s_waitcnt vmcnt(11)
    s_barrier
    s_add_u32 m0, s66, 114688
    s_add_u32 s91, s90, 2
    s_and_b32 s91, s91, 7
    s_mul_i32 s94, s91, 229376
    s_add_u32 s94, s94, s65
    buffer_load_dwordx4 v6, s[28:31], s94 offen offset:0  lds
    buffer_load_dwordx4 v7, s[28:31], s94 offen offset:1024  lds
    buffer_load_dwordx4 v8, s[28:31], s94 offen offset:2048  lds
    buffer_load_dwordx4 v9, s[28:31], s94 offen offset:3072  lds
    s_add_u32 m0, s66, 131072
    s_add_u32 s91, s90, 4
    s_and_b32 s91, s91, 7
    s_mul_i32 s94, s91, 229376
    s_add_u32 s94, s94, s65
    buffer_load_dwordx4 v6, s[28:31], s94 offen offset:0  lds
    buffer_load_dwordx4 v7, s[28:31], s94 offen offset:1024  lds
    buffer_load_dwordx4 v8, s[28:31], s94 offen offset:2048  lds
    buffer_load_dwordx4 v9, s[28:31], s94 offen offset:3072  lds
    s_waitcnt vmcnt(12)
    s_barrier
    s_cmp_lg_u32 s20, 0
    s_cbranch_scc1 L_w02
    s_mov_b32 s63, 0
L_nz3:
    v_and_b32 v20, v20, v21
    v_bitop3_b32 v20, v20, v22, v23 bitop3:0x80
    s_add_u32 s63, s63, 1
    v_readfirstlane_b32 s59, v20
    s_nop 0
    s_cmp_lg_u32 s59, 0
    s_cbranch_scc1 L_nd4
    s_sleep 4
    buffer_load_dwordx4 v[20:23], off, s[44:47], 0 sc1
    s_waitcnt vmcnt(0)
    s_cmp_lt_u32 s63, 0x100000
    s_cbranch_scc1 L_nz3
    s_endpgm
L_nd4:
    s_mov_b32 s61, m0
    s_mov_b32 m0, 4096
    s_lshl_b32 s59, s56, 11
    s_add_u32 s59, s59, 8404992
    buffer_load_dwordx4 v12, s[36:39], s59 offen offset:0 sc1 lds
    buffer_load_dwordx4 v12, s[36:39], s59 offen offset:1024 sc1 lds
    s_mov_b32 m0, 10240
    s_mov_b32 s59, 4096
    buffer_load_dwordx4 v12, s[52:55], s59 offen lds
    s_mov_b32 m0, s61
    s_nop 0
L_w02:
    s_add_u32 m0, s66, 147456
    s_add_u32 s91, s90, 6
    s_and_b32 s91, s91, 7
    s_mul_i32 s94, s91, 229376
    s_add_u32 s94, s94, s65
    buffer_load_dwordx4 v6, s[28:31], s94 offen offset:0  lds
    buffer_load_dwordx4 v7, s[28:31], s94 offen offset:1024  lds
    buffer_load_dwordx4 v8, s[28:31], s94 offen offset:2048  lds
    buffer_load_dwordx4 v9, s[28:31], s94 offen offset:3072  lds
    s_add_u32 m0, s3, 53248
    s_add_u32 s94, s100, 0
    buffer_load_dwordx4 v10, s[32:35], s94 offen offset:0  lds
    buffer_load_dwordx4 v11, s[32:35], s94 offen offset:1024  lds
    s_add_u32 m0, s3, 51200
    s_add_u32 s94, s101, 16384
    buffer_load_dwordx4 v10, s[32:35], s94 offen offset:0  lds
    buffer_load_dwordx4 v11, s[32:35], s94 offen offset:1024  lds
    s_waitcnt vmcnt(16)
    s_barrier
    s_add_u32 m0, s3, 77824
    s_add_u32 s94, s100, 131072
    buffer_load_dwordx4 v10, s[32:35], s94 offen offset:0  lds
    buffer_load_dwordx4 v11, s[32:35], s94 offen offset:1024  lds
    s_waitcnt vmcnt(14)
    s_barrier
    s_add_u32 m0, s3, 75776
    s_add_u32 s94, s101, 147456
    buffer_load_dwordx4 v10, s[32:35], s94 offen offset:0  lds
    buffer_load_dwordx4 v11, s[32:35], s94 offen offset:1024  lds
    s_add_u32 m0, s3, 73728
    s_add_u32 s94, s100, 262144
    buffer_load_dwordx4 v10, s[32:35], s94 offen offset:0  lds
    buffer_load_dwordx4 v11, s[32:35], s94 offen offset:1024  lds
    s_waitcnt vmcnt(10)
    s_barrier
    s_add_u32 m0, s3, 49152
    s_add_u32 s94, s101, 278528
    buffer_load_dwordx4 v10, s[32:35], s94 offen offset:0  lds
    buffer_load_dwordx4 v11, s[32:35], s94 offen offset:1024  lds
    s_add_u32 m0, s3, 28672
    s_add_u32 s94, s100, 393216
    buffer_load_dwordx4 v10, s[32:35], s94 offen offset:0  lds
    buffer_load_dwordx4 v11, s[32:35], s94 offen offset:1024  lds
    s_waitcnt vmcnt(12)
    ds_read_b64_tr_b16 v[128:129], v13 offset:53248
    ds_read_b64_tr_b16 v[130:131], v13 offset:54272
    ds_read_b64_tr_b16 v[132:133], v14 offset:53248
    ds_read_b64_tr_b16 v[134:135], v14 offset:54272
    s_waitcnt lgkmcnt(0)
    s_add_u32 m0, s3, 53248
    s_add_u32 s94, s100, 32768
    buffer_load_dwordx4 v10, s[32:35], s94 offen offset:0  lds
    buffer_load_dwordx4 v11, s[32:35], s94 offen offset:1024  lds
    s_waitcnt vmcnt(12)
    ds_read_b64_tr_b16 v[136:137], v13 offset:51200
    ds_read_b64_tr_b16 v[138:139], v13 offset:52224
    ds_read_b64_tr_b16 v[140:141], v14 offset:51200
    ds_read_b64_tr_b16 v[142:143], v14 offset:52224
    s_waitcnt lgkmcnt(0)
    s_add_u32 m0, s3, 51200
    s_add_u32 s94, s101, 49152
    buffer_load_dwordx4 v10, s[32:35], s94 offen offset:0  lds
    buffer_load_dwordx4 v11, s[32:35], s94 offen offset:1024  lds
    s_waitcnt vmcnt(12)
    ds_read_b64_tr_b16 v[144:145], v15 offset:4096
    ds_read_b64_tr_b16 v[146:147], v15 offset:5120
    ds_read_b64_tr_b16 v[148:149], v16 offset:4096
    ds_read_b64_tr_b16 v[150:151], v16 offset:5120
    s_add_u32 m0, s3, 0
    s_add_u32 s94, s100, 163840
    buffer_load_dwordx4 v10, s[32:35], s94 offen offset:0  lds
    buffer_load_dwordx4 v11, s[32:35], s94 offen offset:1024  lds
    s_waitcnt vmcnt(12)
    ds_read_b64_tr_b16 v[152:153], v15 offset:2048
    ds_read_b64_tr_b16 v[154:155], v15 offset:3072
    ds_read_b64_tr_b16 v[156:157], v16 offset:2048
    ds_read_b64_tr_b16 v[158:159], v16 offset:3072
    s_add_u32 m0, s3, 2048
    s_add_u32 s94, s101, 180224
    buffer_load_dwordx4 v10, s[32:35], s94 offen offset:0  lds
    buffer_load_dwordx4 v11, s[32:35], s94 offen offset:1024  lds
    s_waitcnt vmcnt(12)
    ds_read_b64_tr_b16 v[160:161], v15 offset:0
    ds_read_b64_tr_b16 v[162:163], v15 offset:1024
    ds_read_b64_tr_b16 v[164:165], v16 offset:0
    ds_read_b64_tr_b16 v[166:167], v16 offset:1024
    s_add_u32 m0, s3, 24576
    s_add_u32 s94, s100, 294912
    buffer_load_dwordx4 v10, s[32:35], s94 offen offset:0  lds
    buffer_load_dwordx4 v11, s[32:35], s94 offen offset:1024  lds
    s_waitcnt vmcnt(12)
    ds_read_b64_tr_b16 v[168:169], v13 offset:49152
    ds_read_b64_tr_b16 v[170:171], v13 offset:50176
    ds_read_b64_tr_b16 v[172:173], v14 offset:49152
    ds_read_b64_tr_b16 v[174:175], v14 offset:50176
    s_add_u32 m0, s3, 26624
    s_add_u32 s94, s101, 311296
    buffer_load_dwordx4 v10, s[32:35], s94 offen offset:0  lds
    buffer_load_dwordx4 v11, s[32:35], s94 offen offset:1024  lds
    s_waitcnt vmcnt(12)
    ds_read_b64_tr_b16 v[176:177], v13 offset:28672
    ds_read_b64_tr_b16 v[178:179], v13 offset:29696
    ds_read_b64_tr_b16 v[180:181], v14 offset:28672
    ds_read_b64_tr_b16 v[182:183], v14 offset:29696
    s_waitcnt lgkmcnt(0)
    s_add_u32 m0, s3, 28672
    s_add_u32 s94, s100, 425984
    buffer_load_dwordx4 v10, s[32:35], s94 offen offset:0  lds
    buffer_load_dwordx4 v11, s[32:35], s94 offen offset:1024  lds
    s_waitcnt vmcnt(12)
    ds_read_b64_tr_b16 v[184:185], v13 offset:53248
    ds_read_b64_tr_b16 v[186:187], v13 offset:54272
    ds_read_b64_tr_b16 v[188:189], v14 offset:53248
    ds_read_b64_tr_b16 v[190:191], v14 offset:54272
    s_add_u32 m0, s3, 49152
    s_add_u32 s94, s100, 65536
    buffer_load_dwordx4 v10, s[32:35], s94 offen offset:0  lds
    buffer_load_dwordx4 v11, s[32:35], s94 offen offset:1024  lds
    s_waitcnt vmcnt(12)
    ds_read_b64_tr_b16 v[192:193], v13 offset:51200
    ds_read_b64_tr_b16 v[194:195], v13 offset:52224
    ds_read_b64_tr_b16 v[196:197], v14 offset:51200
    ds_read_b64_tr_b16 v[198:199], v14 offset:52224
    s_waitcnt lgkmcnt(0)
    s_add_u32 m0, s3, 51200
    s_add_u32 s94, s101, 81920
    buffer_load_dwordx4 v10, s[32:35], s94 offen offset:0  lds
    buffer_load_dwordx4 v11, s[32:35], s94 offen offset:1024  lds
    s_add_u32 m0, s3, 53248
    s_add_u32 s94, s100, 196608
    buffer_load_dwordx4 v10, s[32:35], s94 offen offset:0  lds
    buffer_load_dwordx4 v11, s[32:35], s94 offen offset:1024  lds
    s_add_u32 m0, s3, 73728
    s_add_u32 s94, s101, 212992
    buffer_load_dwordx4 v10, s[32:35], s94 offen offset:0  lds
    buffer_load_dwordx4 v11, s[32:35], s94 offen offset:1024  lds
    s_add_u32 m0, s3, 75776
    s_add_u32 s94, s100, 327680
    buffer_load_dwordx4 v10, s[32:35], s94 offen offset:0  lds
    buffer_load_dwordx4 v11, s[32:35], s94 offen offset:1024  lds
    s_add_u32 m0, s3, 77824
    s_add_u32 s94, s101, 344064
    buffer_load_dwordx4 v10, s[32:35], s94 offen offset:0  lds
    buffer_load_dwordx4 v11, s[32:35], s94 offen offset:1024  lds
    s_mov_b32 s63, 0
L_lw5:
    ds_read_b32 v29, v24 offset:10244
    s_waitcnt lgkmcnt(0)
    v_readfirstlane_b32 s62, v29
    s_add_u32 s63, s63, 1
    s_cmp_ge_u32 s62, 4
    s_cbranch_scc1 L_lwd6
    s_sleep 1
    s_cmp_lt_u32 s63, 0x400000
    s_cbranch_scc1 L_lw5
    s_endpgm
L_lwd6:
    s_add_u32 m0, s99, 0
    s_add_u32 s94, s100, 458752
    buffer_load_dwordx4 v10, s[32:35], s94 offen offset:0  lds
    buffer_load_dwordx4 v11, s[32:35], s94 offen offset:1024  lds
    s_add_u32 m0, s99, 2048
    s_add_u32 s94, s100, 98304
    buffer_load_dwordx4 v10, s[32:35], s94 offen offset:0  lds
    buffer_load_dwordx4 v11, s[32:35], s94 offen offset:1024  lds
    s_load_dword s93, s[88:89], 0 glc
    s_add_u32 m0, s99, 4096
    s_add_u32 s94, s101, 114688
    buffer_load_dwordx4 v10, s[32:35], s94 offen offset:0  lds
    buffer_load_dwordx4 v11, s[32:35], s94 offen offset:1024  lds
    s_add_u32 m0, s99, 6144
    s_add_u32 s94, s100, 229376
    buffer_load_dwordx4 v10, s[32:35], s94 offen offset:0  lds
    buffer_load_dwordx4 v11, s[32:35], s94 offen offset:1024  lds
L_p2_join:
    s_mov_b32 s63, 0
L_sp7:
    s_waitcnt lgkmcnt(0)
    s_bfe_u32 s59, s93, 524288
    s_cmp_eq_u32 s59, 8
    s_cbranch_scc1 L_spd8
    s_load_dword s93, s[88:89], 0 glc
    s_add_u32 s63, s63, 1
    s_cmp_lt_u32 s63, 0x400000
    s_cbranch_scc1 L_sp7
    s_endpgm
L_spd8:
    s_add_u32 s97, s95, 0
    buffer_load_dwordx4 v[200:203], v12, s[36:39], s97 offen offset:0 sc1
    s_add_u32 s98, s96, 0
    buffer_load_dwordx4 v[204:207], v12, s[36:39], s98 offen offset:0 sc1
    buffer_load_dwordx4 v[208:211], v12, s[36:39], s97 offen offset:1024 sc1
    buffer_load_dwordx4 v[212:215], v12, s[36:39], s98 offen offset:1024 sc1
    buffer_load_dwordx4 v[216:219], v12, s[36:39], s97 offen offset:2048 sc1
    buffer_load_dwordx4 v[220:223], v12, s[36:39], s98 offen offset:2048 sc1
    buffer_load_dwordx4 v[224:227], v12, s[36:39], s97 offen offset:3072 sc1
    buffer_load_dwordx4 v[228:231], v12, s[36:39], s98 offen offset:3072 sc1
    s_add_u32 s97, s95, 4096
    buffer_load_dwordx4 v[232:235], v12, s[36:39], s97 offen offset:0 sc1
    s_add_u32 s98, s96, 4096
    buffer_load_dwordx4 v[236:239], v12, s[36:39], s98 offen offset:0 sc1
    buffer_load_dwordx4 v[240:243], v12, s[36:39], s97 offen offset:1024 sc1
    buffer_load_dwordx4 v[244:247], v12, s[36:39], s98 offen offset:1024 sc1
    s_load_dword s93, s[88:89], 0 glc
    s_waitcnt vmcnt(10)
    v_mfma_f32_32x32x16_bf16 v[64:79], v[128:131], v[200:203], v[64:79]
    v_mfma_f32_32x32x16_bf16 v[80:95], v[128:131], v[204:207], 0
    v_mfma_f32_32x32x16_bf16 v[96:111], v[132:135], v[200:203], 0
    v_mfma_f32_32x32x16_bf16 v[112:127], v[132:135], v[204:207], 0
    buffer_load_dwordx4 v[248:251], v12, s[36:39], s97 offen offset:2048 sc1
    buffer_load_dwordx4 v[252:255], v12, s[36:39], s98 offen offset:2048 sc1
    s_waitcnt vmcnt(10)
    v_mfma_f32_32x32x16_bf16 v[64:79], v[136:139], v[208:211], v[64:79]
    v_mfma_f32_32x32x16_bf16 v[80:95], v[136:139], v[212:215], v[80:95]
    v_mfma_f32_32x32x16_bf16 v[96:111], v[140:143], v[208:211], v[96:111]
    v_mfma_f32_32x32x16_bf16 v[112:127], v[140:143], v[212:215], v[112:127]
    s_mov_b32 s63, 0
L_sp9:
    s_waitcnt lgkmcnt(0)
    s_bfe_u32 s59, s93, 524296
    s_cmp_eq_u32 s59, 8
    s_cbranch_scc1 L_spd10
    s_load_dword s93, s[88:89], 0 glc
    s_add_u32 s63, s63, 1
    s_cmp_lt_u32 s63, 0x400000
    s_cbranch_scc1 L_sp9
    s_endpgm
L_spd10:
    s_add_u32 s97, s95, 28672
    buffer_load_dwordx4 v[128:131], v12, s[36:39], s97 offen offset:0 sc1
    s_add_u32 s98, s96, 28672
    buffer_load_dwordx4 v[132:135], v12, s[36:39], s98 offen offset:0 sc1
    s_waitcnt vmcnt(10)
    v_mfma_f32_32x32x16_bf16 v[64:79], v[144:147], v[216:219], v[64:79]
    v_mfma_f32_32x32x16_bf16 v[80:95], v[144:147], v[220:223], v[80:95]
    v_mfma_f32_32x32x16_bf16 v[96:111], v[148:151], v[216:219], v[96:111]
    v_mfma_f32_32x32x16_bf16 v[112:127], v[148:151], v[220:223], v[112:127]
    buffer_load_dwordx4 v[200:203], v12, s[36:39], s97 offen offset:1024 sc1
    buffer_load_dwordx4 v[204:207], v12, s[36:39], s98 offen offset:1024 sc1
    s_cmp_ge_u32 s22, 28
    s_cbranch_scc1 L_nrw11
    s_mov_b32 s63, 0
L_lw12:
    ds_read_b32 v29, v24 offset:10240
    s_waitcnt lgkmcnt(0)
    v_readfirstlane_b32 s62, v29
    s_add_u32 s63, s63, 1
    s_cmp_ge_u32 s62, 4
    s_cbranch_scc1 L_lwd13
    s_sleep 1
    s_cmp_lt_u32 s63, 0x400000
    s_cbranch_scc1 L_lw12
    s_endpgm
L_lwd13:
L_nrw11:
    s_add_u32 m0, s99, 32768
    s_add_u32 s94, s101, 245760
    buffer_load_dwordx4 v10, s[32:35], s94 offen offset:0  lds
    buffer_load_dwordx4 v11, s[32:35], s94 offen offset:1024  lds
    s_waitcnt vmcnt(12)
    v_mfma_f32_32x32x16_bf16 v[64:79], v[152:155], v[224:227], v[64:79]
    v_mfma_f32_32x32x16_bf16 v[80:95], v[152:155], v[228:231], v[80:95]
    v_mfma_f32_32x32x16_bf16 v[96:111], v[156:159], v[224:227], v[96:111]
    v_mfma_f32_32x32x16_bf16 v[112:127], v[156:159], v[228:231], v[112:127]
    buffer_load_dwordx4 v[136:139], v12, s[36:39], s97 offen offset:2048 sc1
    buffer_load_dwordx4 v[140:143], v12, s[36:39], s98 offen offset:2048 sc1
    s_add_u32 m0, s99, 34816
    s_add_u32 s94, s100, 360448
    buffer_load_dwordx4 v10, s[32:35], s94 offen offset:0  lds
    buffer_load_dwordx4 v11, s[32:35], s94 offen offset:1024  lds
    s_waitcnt vmcnt(14)
    v_mfma_f32_32x32x16_bf16 v[64:79], v[160:163], v[232:235], v[64:79]
    v_mfma_f32_32x32x16_bf16 v[80:95], v[160:163], v[236:239], v[80:95]
    v_mfma_f32_32x32x16_bf16 v[96:111], v[164:167], v[232:235], v[96:111]
    v_mfma_f32_32x32x16_bf16 v[112:127], v[164:167], v[236:239], v[112:127]
    buffer_load_dwordx4 v[208:211], v12, s[36:39], s97 offen offset:3072 sc1
    buffer_load_dwordx4 v[212:215], v12, s[36:39], s98 offen offset:3072 sc1
    s_add_u32 m0, s99, 36864
    s_add_u32 s94, s101, 376832
    buffer_load_dwordx4 v10, s[32:35], s94 offen offset:0  lds
    buffer_load_dwordx4 v11, s[32:35], s94 offen offset:1024  lds
    s_waitcnt vmcnt(16)
    v_mfma_f32_32x32x16_bf16 v[64:79], v[168:171], v[240:243], v[64:79]
    v_mfma_f32_32x32x16_bf16 v[80:95], v[168:171], v[244:247], v[80:95]
    v_mfma_f32_32x32x16_bf16 v[96:111], v[172:175], v[240:243], v[96:111]
    v_mfma_f32_32x32x16_bf16 v[112:127], v[172:175], v[244:247], v[112:127]
    s_add_u32 s97, s95, 32768
    buffer_load_dwordx4 v[144:147], v12, s[36:39], s97 offen offset:0 sc1
    s_add_u32 s98, s96, 32768
    buffer_load_dwordx4 v[148:151], v12, s[36:39], s98 offen offset:0 sc1
    s_add_u32 m0, s99, 38912
    s_add_u32 s94, s100, 491520
    buffer_load_dwordx4 v10, s[32:35], s94 offen offset:0  lds
    buffer_load_dwordx4 v11, s[32:35], s94 offen offset:1024  lds
    s_load_dword s93, s[88:89], 0 glc
    s_waitcnt vmcnt(18)
    v_mfma_f32_32x32x16_bf16 v[64:79], v[176:179], v[248:251], v[64:79]
    v_mfma_f32_32x32x16_bf16 v[80:95], v[176:179], v[252:255], v[80:95]
    v_mfma_f32_32x32x16_bf16 v[96:111], v[180:183], v[248:251], v[96:111]
    v_mfma_f32_32x32x16_bf16 v[112:127], v[180:183], v[252:255], v[112:127]
    buffer_load_dwordx4 v[216:219], v12, s[36:39], s97 offen offset:1024 sc1
    buffer_load_dwordx4 v[220:223], v12, s[36:39], s98 offen offset:1024 sc1
    s_waitcnt vmcnt(18)
    v_mfma_f32_32x32x16_bf16 v[64:79], v[184:187], v[128:131], v[64:79]
    ds_read_b64_tr_b16 v[40:41], v13 offset:0
    ds_read_b64_tr_b16 v[42:43], v13 offset:1024
    v_mfma_f32_32x32x16_bf16 v[80:95], v[184:187], v[132:135], v[80:95]
    ds_read_b64_tr_b16 v[44:45], v14 offset:0
    ds_read_b64_tr_b16 v[46:47], v14 offset:1024
    v_mfma_f32_32x32x16_bf16 v[96:111], v[188:191], v[128:131], v[96:111]
    v_mfma_f32_32x32x16_bf16 v[112:127], v[188:191], v[132:135], v[112:127]
    buffer_load_dwordx4 v[152:155], v12, s[36:39], s97 offen offset:2048 sc1
    buffer_load_dwordx4 v[156:159], v12, s[36:39], s98 offen offset:2048 sc1
    s_waitcnt vmcnt(18)
    v_mfma_f32_32x32x16_bf16 v[64:79], v[192:195], v[200:203], v[64:79]
    ds_read_b64_tr_b16 v[48:49], v13 offset:2048
    ds_read_b64_tr_b16 v[50:51], v13 offset:3072
    v_mfma_f32_32x32x16_bf16 v[80:95], v[192:195], v[204:207], v[80:95]
    ds_read_b64_tr_b16 v[52:53], v14 offset:2048
    ds_read_b64_tr_b16 v[54:55], v14 offset:3072
    v_mfma_f32_32x32x16_bf16 v[96:111], v[196:199], v[200:203], v[96:111]
    v_mfma_f32_32x32x16_bf16 v[112:127], v[196:199], v[204:207], v[112:127]
    s_mov_b32 s63, 0
L_sp14:
    s_waitcnt lgkmcnt(0)
    s_bfe_u32 s59, s93, 524304
    s_cmp_eq_u32 s59, 8
    s_cbranch_scc1 L_spd15
    s_load_dword s93, s[88:89], 0 glc
    s_add_u32 s63, s63, 1
    s_cmp_lt_u32 s63, 0x400000
    s_cbranch_scc1 L_sp14
    s_endpgm
L_spd15:
    s_add_u32 s97, s95, 57344
    buffer_load_dwordx4 v[224:227], v12, s[36:39], s97 offen offset:0 sc1
    s_add_u32 s98, s96, 57344
    buffer_load_dwordx4 v[228:231], v12, s[36:39], s98 offen offset:0 sc1
    s_waitcnt vmcnt(16)
    v_mfma_f32_32x32x16_bf16 v[64:79], v[40:43], v[136:139], v[64:79]
    ds_read_b64_tr_b16 v[56:57], v13 offset:24576
    ds_read_b64_tr_b16 v[58:59], v13 offset:25600
    v_mfma_f32_32x32x16_bf16 v[80:95], v[40:43], v[140:143], v[80:95]
    ds_read_b64_tr_b16 v[60:61], v14 offset:24576
    ds_read_b64_tr_b16 v[62:63], v14 offset:25600
    v_mfma_f32_32x32x16_bf16 v[96:111], v[44:47], v[136:139], v[96:111]
    v_mfma_f32_32x32x16_bf16 v[112:127], v[44:47], v[140:143], v[112:127]
    buffer_load_dwordx4 v[160:163], v12, s[36:39], s97 offen offset:1024 sc1
    buffer_load_dwordx4 v[164:167], v12, s[36:39], s98 offen offset:1024 sc1
    s_waitcnt vmcnt(14)
    v_mfma_f32_32x32x16_bf16 v[64:79], v[48:51], v[208:211], v[64:79]
    ds_read_b64_tr_b16 v[40:41], v13 offset:26624
    ds_read_b64_tr_b16 v[42:43], v13 offset:27648
    v_mfma_f32_32x32x16_bf16 v[80:95], v[48:51], v[212:215], v[80:95]
    ds_read_b64_tr_b16 v[44:45], v14 offset:26624
    ds_read_b64_tr_b16 v[46:47], v14 offset:27648
    v_mfma_f32_32x32x16_bf16 v[96:111], v[52:55], v[208:211], v[96:111]
    v_mfma_f32_32x32x16_bf16 v[112:127], v[52:55], v[212:215], v[112:127]
    buffer_load_dwordx4 v[232:235], v12, s[36:39], s97 offen offset:2048 sc1
    buffer_load_dwordx4 v[236:239], v12, s[36:39], s98 offen offset:2048 sc1
    s_waitcnt vmcnt(12)
    s_waitcnt lgkmcnt(4)
    v_mfma_f32_32x32x16_bf16 v[64:79], v[56:59], v[144:147], v[64:79]
    ds_read_b64_tr_b16 v[48:49], v13 offset:28672
    ds_read_b64_tr_b16 v[50:51], v13 offset:29696
    v_mfma_f32_32x32x16_bf16 v[80:95], v[56:59], v[148:151], v[80:95]
    ds_read_b64_tr_b16 v[52:53], v14 offset:28672
    ds_read_b64_tr_b16 v[54:55], v14 offset:29696
    v_mfma_f32_32x32x16_bf16 v[96:111], v[60:63], v[144:147], v[96:111]
    v_mfma_f32_32x32x16_bf16 v[112:127], v[60:63], v[148:151], v[112:127]
    buffer_load_dwordx4 v[168:171], v12, s[36:39], s97 offen offset:3072 sc1
    buffer_load_dwordx4 v[172:175], v12, s[36:39], s98 offen offset:3072 sc1
    s_waitcnt vmcnt(10)
    s_waitcnt lgkmcnt(4)
    v_mfma_f32_32x32x16_bf16 v[64:79], v[40:43], v[216:219], v[64:79]
    ds_read_b64_tr_b16 v[56:57], v13 offset:49152
    ds_read_b64_tr_b16 v[58:59], v13 offset:50176
    v_mfma_f32_32x32x16_bf16 v[80:95], v[40:43], v[220:223], v[80:95]
    ds_read_b64_tr_b16 v[60:61], v14 offset:49152
    ds_read_b64_tr_b16 v[62:63], v14 offset:50176
    v_mfma_f32_32x32x16_bf16 v[96:111], v[44:47], v[216:219], v[96:111]
    v_mfma_f32_32x32x16_bf16 v[112:127], v[44:47], v[220:223], v[112:127]
    s_add_u32 s97, s95, 61440
    buffer_load_dwordx4 v[240:243], v12, s[36:39], s97 offen offset:0 sc1
    s_add_u32 s98, s96, 61440
    buffer_load_dwordx4 v[244:247], v12, s[36:39], s98 offen offset:0 sc1
    s_load_dword s93, s[88:89], 0 glc
    s_waitcnt vmcnt(10)
    s_waitcnt lgkmcnt(4)
    v_mfma_f32_32x32x16_bf16 v[64:79], v[48:51], v[152:155], v[64:79]
    ds_read_b64_tr_b16 v[40:41], v13 offset:51200
    ds_read_b64_tr_b16 v[42:43], v13 offset:52224
    v_mfma_f32_32x32x16_bf16 v[80:95], v[48:51], v[156:159], v[80:95]
    ds_read_b64_tr_b16 v[44:45], v14 offset:51200
    ds_read_b64_tr_b16 v[46:47], v14 offset:52224
    v_mfma_f32_32x32x16_bf16 v[96:111], v[52:55], v[152:155], v[96:111]
    v_mfma_f32_32x32x16_bf16 v[112:127], v[52:55], v[156:159], v[112:127]
    buffer_load_dwordx4 v[176:179], v12, s[36:39], s97 offen offset:1024 sc1
    buffer_load_dwordx4 v[180:183], v12, s[36:39], s98 offen offset:1024 sc1
    s_waitcnt vmcnt(10)
    s_waitcnt lgkmcnt(4)
    v_mfma_f32_32x32x16_bf16 v[64:79], v[56:59], v[224:227], v[64:79]
    ds_read_b64_tr_b16 v[48:49], v13 offset:53248
    ds_read_b64_tr_b16 v[50:51], v13 offset:54272
    v_mfma_f32_32x32x16_bf16 v[80:95], v[56:59], v[228:231], v[80:95]
    ds_read_b64_tr_b16 v[52:53], v14 offset:53248
    ds_read_b64_tr_b16 v[54:55], v14 offset:54272
    v_mfma_f32_32x32x16_bf16 v[96:111], v[60:63], v[224:227], v[96:111]
    v_mfma_f32_32x32x16_bf16 v[112:127], v[60:63], v[228:231], v[112:127]
    buffer_load_dwordx4 v[248:251], v12, s[36:39], s97 offen offset:2048 sc1
    buffer_load_dwordx4 v[252:255], v12, s[36:39], s98 offen offset:2048 sc1
    s_waitcnt vmcnt(10)
    s_waitcnt lgkmcnt(4)
    v_mfma_f32_32x32x16_bf16 v[64:79], v[40:43], v[160:163], v[64:79]
    ds_read_b64_tr_b16 v[56:57], v15 offset:0
    ds_read_b64_tr_b16 v[58:59], v15 offset:1024
    v_mfma_f32_32x32x16_bf16 v[80:95], v[40:43], v[164:167], v[80:95]
    ds_read_b64_tr_b16 v[60:61], v16 offset:0
    ds_read_b64_tr_b16 v[62:63], v16 offset:1024
    v_mfma_f32_32x32x16_bf16 v[96:111], v[44:47], v[160:163], v[96:111]
    v_mfma_f32_32x32x16_bf16 v[112:127], v[44:47], v[164:167], v[112:127]
    s_mov_b32 s63, 0
L_sp16:
    s_waitcnt lgkmcnt(0)
    s_bfe_u32 s59, s93, 524312
    s_cmp_eq_u32 s59, 8
    s_cbranch_scc1 L_spd17
    s_load_dword s93, s[88:89], 0 glc
    s_add_u32 s63, s63, 1
    s_cmp_lt_u32 s63, 0x400000
    s_cbranch_scc1 L_sp16
    s_endpgm
L_spd17:
    s_add_u32 s97, s95, 86016
    buffer_load_dwordx4 v[128:131], v12, s[36:39], s97 offen offset:0 sc1
    s_add_u32 s98, s96, 86016
    buffer_load_dwordx4 v[132:135], v12, s[36:39], s98 offen offset:0 sc1
    s_waitcnt vmcnt(10)
    v_mfma_f32_32x32x16_bf16 v[64:79], v[48:51], v[232:235], v[64:79]
    ds_read_b64_tr_b16 v[40:41], v15 offset:2048
    ds_read_b64_tr_b16 v[42:43], v15 offset:3072
    v_mfma_f32_32x32x16_bf16 v[80:95], v[48:51], v[236:239], v[80:95]
    ds_read_b64_tr_b16 v[44:45], v16 offset:2048
    ds_read_b64_tr_b16 v[46:47], v16 offset:3072
    v_mfma_f32_32x32x16_bf16 v[96:111], v[52:55], v[232:235], v[96:111]
    v_mfma_f32_32x32x16_bf16 v[112:127], v[52:55], v[236:239], v[112:127]
    buffer_load_dwordx4 v[184:187], v12, s[36:39], s97 offen offset:1024 sc1
    buffer_load_dwordx4 v[188:191], v12, s[36:39], s98 offen offset:1024 sc1
    s_waitcnt vmcnt(10)
    v_mfma_f32_32x32x16_bf16 v[64:79], v[56:59], v[168:171], v[64:79]
    ds_read_b64_tr_b16 v[48:49], v15 offset:4096
    ds_read_b64_tr_b16 v[50:51], v15 offset:5120
    v_mfma_f32_32x32x16_bf16 v[80:95], v[56:59], v[172:175], v[80:95]
    ds_read_b64_tr_b16 v[52:53], v16 offset:4096
    ds_read_b64_tr_b16 v[54:55], v16 offset:5120
    v_mfma_f32_32x32x16_bf16 v[96:111], v[60:63], v[168:171], v[96:111]
    v_mfma_f32_32x32x16_bf16 v[112:127], v[60:63], v[172:175], v[112:127]
    buffer_load_dwordx4 v[192:195], v12, s[36:39], s97 offen offset:2048 sc1
    buffer_load_dwordx4 v[196:199], v12, s[36:39], s98 offen offset:2048 sc1
    s_waitcnt vmcnt(10)
    s_waitcnt lgkmcnt(4)
    v_mfma_f32_32x32x16_bf16 v[64:79], v[40:43], v[240:243], v[64:79]
    ds_read_b64_tr_b16 v[216:217], v17 offset:0
    ds_read_b64_tr_b16 v[218:219], v17 offset:1024
    v_mfma_f32_32x32x16_bf16 v[80:95], v[40:43], v[244:247], v[80:95]
    ds_read_b64_tr_b16 v[60:61], v18 offset:0
    ds_read_b64_tr_b16 v[62:63], v18 offset:1024
    v_mfma_f32_32x32x16_bf16 v[96:111], v[44:47], v[240:243], v[96:111]
    v_mfma_f32_32x32x16_bf16 v[112:127], v[44:47], v[244:247], v[112:127]
    buffer_load_dwordx4 v[200:203], v12, s[36:39], s97 offen offset:3072 sc1
    buffer_load_dwordx4 v[204:207], v12, s[36:39], s98 offen offset:3072 sc1
    s_waitcnt vmcnt(10)
    s_waitcnt lgkmcnt(4)
    v_mfma_f32_32x32x16_bf16 v[64:79], v[48:51], v[176:179], v[64:79]
    ds_read_b64_tr_b16 v[220:221], v17 offset:2048
    ds_read_b64_tr_b16 v[222:223], v17 offset:3072
    v_mfma_f32_32x32x16_bf16 v[80:95], v[48:51], v[180:183], v[80:95]
    ds_read_b64_tr_b16 v[44:45], v18 offset:2048
    ds_read_b64_tr_b16 v[46:47], v18 offset:3072
    v_mfma_f32_32x32x16_bf16 v[96:111], v[52:55], v[176:179], v[96:111]
    v_mfma_f32_32x32x16_bf16 v[112:127], v[52:55], v[180:183], v[112:127]
    s_add_u32 s97, s95, 90112
    buffer_load_dwordx4 v[136:139], v12, s[36:39], s97 offen offset:0 sc1
    s_add_u32 s98, s96, 90112
    buffer_load_dwordx4 v[140:143], v12, s[36:39], s98 offen offset:0 sc1
    s_waitcnt vmcnt(10)
    s_waitcnt lgkmcnt(4)
    v_mfma_f32_32x32x16_bf16 v[80:95], v[216:219], v[252:255], v[80:95]
    ds_read_b64_tr_b16 v[152:153], v17 offset:4096
    ds_read_b64_tr_b16 v[154:155], v17 offset:5120
    v_mfma_f32_32x32x16_bf16 v[96:111], v[60:63], v[248:251], v[96:111]
    ds_read_b64_tr_b16 v[52:53], v18 offset:4096
    ds_read_b64_tr_b16 v[54:55], v18 offset:5120
    v_mfma_f32_32x32x16_bf16 v[112:127], v[60:63], v[252:255], v[112:127]
    buffer_load_dwordx4 v[208:211], v12, s[36:39], s97 offen offset:1024 sc1
    buffer_load_dwordx4 v[212:215], v12, s[36:39], s98 offen offset:1024 sc1
    s_waitcnt vmcnt(10)
    s_waitcnt lgkmcnt(4)
    v_mfma_f32_32x32x16_bf16 v[80:95], v[220:223], v[132:135], v[80:95]
    ds_read_b64_tr_b16 v[156:157], v17 offset:6144
    ds_read_b64_tr_b16 v[158:159], v17 offset:7168
    v_mfma_f32_32x32x16_bf16 v[96:111], v[44:47], v[128:131], v[96:111]
    ds_read_b64_tr_b16 v[60:61], v18 offset:6144
    ds_read_b64_tr_b16 v[62:63], v18 offset:7168
    v_mfma_f32_32x32x16_bf16 v[112:127], v[44:47], v[132:135], v[112:127]
    buffer_load_dwordx4 v[144:147], v12, s[36:39], s97 offen offset:2048 sc1
    buffer_load_dwordx4 v[148:151], v12, s[36:39], s98 offen offset:2048 sc1
    s_waitcnt vmcnt(10)
    s_waitcnt lgkmcnt(4)
    v_mfma_f32_32x32x16_bf16 v[80:95], v[152:155], v[188:191], v[80:95]
    ds_read_b64_tr_b16 v[224:225], v17 offset:32768
    ds_read_b64_tr_b16 v[226:227], v17 offset:33792
    v_mfma_f32_32x32x16_bf16 v[96:111], v[52:55], v[184:187], v[96:111]
    ds_read_b64_tr_b16 v[44:45], v18 offset:32768
    ds_read_b64_tr_b16 v[46:47], v18 offset:33792
    v_mfma_f32_32x32x16_bf16 v[112:127], v[52:55], v[188:191], v[112:127]
    s_waitcnt vmcnt(8)
    s_waitcnt lgkmcnt(4)
    v_mfma_f32_32x32x16_bf16 v[80:95], v[156:159], v[196:199], v[80:95]
    ds_read_b64_tr_b16 v[228:229], v17 offset:34816
    ds_read_b64_tr_b16 v[230:231], v17 offset:35840
    v_mfma_f32_32x32x16_bf16 v[96:111], v[60:63], v[192:195], v[96:111]
    ds_read_b64_tr_b16 v[52:53], v18 offset:34816
    ds_read_b64_tr_b16 v[54:55], v18 offset:35840
    v_mfma_f32_32x32x16_bf16 v[112:127], v[60:63], v[196:199], v[112:127]
    s_waitcnt vmcnt(6)
    s_waitcnt lgkmcnt(4)
    v_mfma_f32_32x32x16_bf16 v[80:95], v[224:227], v[204:207], v[80:95]
    ds_read_b64_tr_b16 v[160:161], v17 offset:36864
    ds_read_b64_tr_b16 v[162:163], v17 offset:37888
    v_mfma_f32_32x32x16_bf16 v[96:111], v[44:47], v[200:203], v[96:111]
    ds_read_b64_tr_b16 v[60:61], v18 offset:36864
    ds_read_b64_tr_b16 v[62:63], v18 offset:37888
    v_mfma_f32_32x32x16_bf16 v[112:127], v[44:47], v[204:207], v[112:127]
    s_waitcnt vmcnt(4)
    s_waitcnt lgkmcnt(4)
    v_mfma_f32_32x32x16_bf16 v[80:95], v[228:231], v[140:143], v[80:95]
    ds_read_b64_tr_b16 v[164:165], v17 offset:38912
    ds_read_b64_tr_b16 v[166:167], v17 offset:39936
    v_mfma_f32_32x32x16_bf16 v[96:111], v[52:55], v[136:139], v[96:111]
    ds_read_b64_tr_b16 v[44:45], v18 offset:38912
    ds_read_b64_tr_b16 v[46:47], v18 offset:39936
    v_mfma_f32_32x32x16_bf16 v[112:127], v[52:55], v[140:143], v[112:127]
    s_waitcnt vmcnt(2)
    s_waitcnt lgkmcnt(4)
    v_mfma_f32_32x32x16_bf16 v[80:95], v[160:163], v[212:215], v[80:95]
    v_mfma_f32_32x32x16_bf16 v[96:111], v[60:63], v[208:211], v[96:111]
    v_mfma_f32_32x32x16_bf16 v[112:127], v[60:63], v[212:215], v[112:127]
    s_waitcnt vmcnt(0)
    s_waitcnt lgkmcnt(0)
    v_mfma_f32_32x32x16_bf16 v[80:95], v[164:167], v[148:151], v[80:95]
    v_mfma_f32_32x32x16_bf16 v[96:111], v[44:47], v[144:147], v[96:111]
    v_mfma_f32_32x32x16_bf16 v[112:127], v[44:47], v[148:151], v[112:127]
    v_mfma_f32_32x32x16_bf16 v[64:79], v[216:219], v[248:251], v[64:79]
    s_nop 8
    ds_write_b128 v37, v[80:83] offset:0
    ds_write_b128 v37, v[84:87] offset:1024
    v_mfma_f32_32x32x16_bf16 v[64:79], v[220:223], v[128:131], v[64:79]
    ds_write_b128 v37, v[88:91] offset:2048
    ds_write_b128 v37, v[92:95] offset:3072
    v_mfma_f32_32x32x16_bf16 v[64:79], v[152:155], v[184:187], v[64:79]
    ds_write_b128 v37, v[96:99] offset:4096
    v_mfma_f32_32x32x16_bf16 v[64:79], v[156:159], v[192:195], v[64:79]
    ds_write_b128 v37, v[100:103] offset:5120
    ds_write_b128 v37, v[104:107] offset:6144
    v_mfma_f32_32x32x16_bf16 v[64:79], v[224:227], v[200:203], v[64:79]
    ds_write_b128 v37, v[108:111] offset:7168
    v_mfma_f32_32x32x16_bf16 v[64:79], v[228:231], v[136:139], v[64:79]
    ds_write_b128 v37, v[112:115] offset:32768
    ds_write_b128 v37, v[116:119] offset:33792
    v_mfma_f32_32x32x16_bf16 v[64:79], v[160:163], v[208:211], v[64:79]
    ds_write_b128 v37, v[120:123] offset:34816
    v_mfma_f32_32x32x16_bf16 v[64:79], v[164:167], v[144:147], v[64:79]
    ds_write_b128 v37, v[124:127] offset:35840
    s_waitcnt lgkmcnt(0)
    s_barrier
    ds_read_b128 v[128:131], v25 offset:0
    ds_read_b128 v[132:135], v25 offset:1024
    ds_read_b128 v[144:147], v26 offset:0
    ds_read_b128 v[148:151], v26 offset:1024
    ds_read_b128 v[160:163], v27 offset:0
    ds_read_b128 v[164:167], v27 offset:1024
    ds_read_b128 v[136:139], v25 offset:2048
    ds_read_b128 v[140:143], v25 offset:3072
    ds_read_b128 v[152:155], v26 offset:2048
    ds_read_b128 v[156:159], v26 offset:3072
    ds_read_b128 v[168:171], v27 offset:2048
    ds_read_b128 v[172:175], v27 offset:3072
    s_waitcnt lgkmcnt(10)
    v_pk_add_f32 v[64:65], v[64:65], v[128:129]
    v_pk_add_f32 v[66:67], v[66:67], v[130:131]
    v_pk_add_f32 v[68:69], v[68:69], v[132:133]
    v_pk_add_f32 v[70:71], v[70:71], v[134:135]
    s_waitcnt lgkmcnt(8)
    v_pk_add_f32 v[64:65], v[64:65], v[144:145]
    v_pk_add_f32 v[66:67], v[66:67], v[146:147]
    v_pk_add_f32 v[68:69], v[68:69], v[148:149]
    v_pk_add_f32 v[70:71], v[70:71], v[150:151]
    s_waitcnt lgkmcnt(6)
    v_pk_add_f32 v[64:65], v[64:65], v[160:161]
    v_pk_add_f32 v[66:67], v[66:67], v[162:163]
    v_pk_add_f32 v[68:69], v[68:69], v[164:165]
    v_pk_add_f32 v[70:71], v[70:71], v[166:167]
    v_cvt_pk_bf16_f32 v48, v64, v65
    v_cvt_pk_bf16_f32 v49, v66, v67
    v_cvt_pk_bf16_f32 v50, v68, v69
    v_cvt_pk_bf16_f32 v51, v70, v71
    ds_write2_b64 v38, v[48:49], v[50:51] offset0:0 offset1:2
    s_waitcnt lgkmcnt(5)
    v_pk_add_f32 v[72:73], v[72:73], v[136:137]
    v_pk_add_f32 v[74:75], v[74:75], v[138:139]
    v_pk_add_f32 v[76:77], v[76:77], v[140:141]
    v_pk_add_f32 v[78:79], v[78:79], v[142:143]
    s_waitcnt lgkmcnt(3)
    v_pk_add_f32 v[72:73], v[72:73], v[152:153]
    v_pk_add_f32 v[74:75], v[74:75], v[154:155]
    v_pk_add_f32 v[76:77], v[76:77], v[156:157]
    v_pk_add_f32 v[78:79], v[78:79], v[158:159]
    s_waitcnt lgkmcnt(1)
    v_pk_add_f32 v[72:73], v[72:73], v[168:169]
    v_pk_add_f32 v[74:75], v[74:75], v[170:171]
    v_pk_add_f32 v[76:77], v[76:77], v[172:173]
    v_pk_add_f32 v[78:79], v[78:79], v[174:175]
    v_cvt_pk_bf16_f32 v52, v72, v73
    v_cvt_pk_bf16_f32 v53, v74, v75
    v_cvt_pk_bf16_f32 v54, v76, v77
    v_cvt_pk_bf16_f32 v55, v78, v79
    ds_write2_b64 v38, v[52:53], v[54:55] offset0:4 offset1:6
    s_mov_b32 s59, 8192
    s_waitcnt lgkmcnt(0)
    s_barrier
    ds_read_b128 v[56:59], v39 offset:0
    ds_read_b128 v[60:63], v39 offset:1152
    s_waitcnt lgkmcnt(1)
    buffer_store_dwordx4 v[56:59], v36, s[40:43], 0 offen sc1
    s_waitcnt lgkmcnt(0)
    buffer_store_dwordx4 v[60:63], v36, s[40:43], s59 offen sc1
    s_endpgm
L_p1:
    s_sub_u32 s20, s20, 4
    v_bfe_u32 v32, v1, 1, 3
    v_lshrrev_b32 v33, 5, v1
    v_xor_b32 v32, v32, v33
    v_lshlrev_b32 v32, 4, v32
    v_and_b32 v34, 31, v1
    v_lshl_add_u32 v32, v34, 7, v32
    s_lshl_b32 s59, s20, 12
    v_add_u32 v2, s59, v32
    v_xor_b32 v3, 32, v2
    v_xor_b32 v4, 64, v2
    v_xor_b32 v5, 96, v2
    v_add_u32 v6, 73728, v2
    v_add_u32 v7, 73728, v3
    v_add_u32 v8, 73728, v4
    v_add_u32 v9, 73728, v5
    v_lshlrev_b32 v29, 3, v34
    v_add_u32 v29, 4096, v29
    v_add_u32 v28, -1, v33
    v_bfe_u32 v32, v1, 2, 2
    v_and_b32 v34, 3, v1
    v_lshlrev_b32 v34, 3, v34
    v_lshl_add_u32 v34, v32, 7, v34
    v_bfe_u32 v32, v1, 3, 1
    v_lshl_add_u32 v34, v32, 6, v34
    v_lshl_add_u32 v34, v33, 10, v34
    v_bfe_u32 v32, v1, 4, 1
    v_lshl_add_u32 v34, v32, 5, v34
    v_xor_b32 v35, 64, v34
    v_add_u32 v10, 16384, v34
    v_add_u32 v12, 90112, v34
    v_add_u32 v14, 98304, v34
    v_add_u32 v11, 16384, v35
    v_add_u32 v13, 90112, v35
    v_add_u32 v15, 98304, v35
    v_lshlrev_b32 v30, 4, v1
    v_mov_b32 v16, 0
    v_mov_b32 v17, 0
    v_mov_b32 v18, 0
    v_mov_b32 v19, 0
    s_mov_b32 s66, 0x3f803f80
    s_lshl2_add_u32 s59, s23, s20
    s_mul_i32 s64, s59, 114688
    s_lshl_b32 s60, s56, 11
    s_add_u32 s64, s64, s60
    s_lshr_b32 s68, s59, 1
    s_mul_i32 s60, s56, 37
    s_lshr_b32 s61, s60, 7
    s_add_u32 s60, s60, 18
    s_lshr_b32 s60, s60, 7
    s_lshl2_add_u32 s68, s68, s61
    s_mul_i32 s68, s68, 128
    s_add_u32 s68, s68, 8388608
    s_cmp_eq_u32 s60, s61
    s_cselect_b32 s84, 1, 3
    s_waitcnt lgkmcnt(0)
    s_mov_b64 s[36:37], s[18:19]
    s_mov_b32 s38, 268435456
    s_mov_b32 s39, 0x00020000
    s_setprio 2
    s_barrier
    ds_read_b128 v[128:131], v2 offset:0
    ds_read_b64_tr_b16 v[32:33], v10 offset:0
    ds_read_b64_tr_b16 v[34:35], v10 offset:512
    ds_read_b64_tr_b16 v[36:37], v11 offset:0
    ds_read_b64_tr_b16 v[38:39], v11 offset:512
    ds_read_b128 v[132:135], v3 offset:0
    ds_read_b64_tr_b16 v[40:41], v10 offset:2048
    ds_read_b64_tr_b16 v[42:43], v10 offset:2560
    ds_read_b64_tr_b16 v[44:45], v11 offset:2048
    ds_read_b64_tr_b16 v[46:47], v11 offset:2560
    s_waitcnt lgkmcnt(5)
    v_mfma_f32_32x32x16_bf16 v[64:79], v[32:35], v[128:131], 0
    ds_read_b128 v[136:139], v4 offset:0
    ds_read_b64_tr_b16 v[48:49], v10 offset:4096
    ds_read_b64_tr_b16 v[50:51], v10 offset:4608
    v_mfma_f32_32x32x16_bf16 v[80:95], v[36:39], v[128:131], 0
    ds_read_b64_tr_b16 v[52:53], v11 offset:4096
    ds_read_b64_tr_b16 v[54:55], v11 offset:4608
    s_waitcnt lgkmcnt(5)
    v_mfma_f32_32x32x16_bf16 v[64:79], v[40:43], v[132:135], v[64:79]
    ds_read_b128 v[140:143], v5 offset:0
    ds_read_b64_tr_b16 v[56:57], v10 offset:6144
    ds_read_b64_tr_b16 v[58:59], v10 offset:6656
    v_mfma_f32_32x32x16_bf16 v[80:95], v[44:47], v[132:135], v[80:95]
    ds_read_b64_tr_b16 v[60:61], v11 offset:6144
    ds_read_b64_tr_b16 v[62:63], v11 offset:6656
    v_dot2c_f32_bf16 v16, v128, v128
    v_dot2c_f32_bf16 v18, s66, v128
    v_dot2c_f32_bf16 v17, v129, v129
    v_dot2c_f32_bf16 v19, s66, v129
    v_dot2c_f32_bf16 v16, v130, v130
    v_dot2c_f32_bf16 v18, s66, v130
    v_dot2c_f32_bf16 v17, v131, v131
    v_dot2c_f32_bf16 v19, s66, v131
    v_dot2c_f32_bf16 v16, v132, v132
    v_dot2c_f32_bf16 v18, s66, v132
    v_dot2c_f32_bf16 v17, v133, v133
    v_dot2c_f32_bf16 v19, s66, v133
    v_dot2c_f32_bf16 v16, v134, v134
    v_dot2c_f32_bf16 v18, s66, v134
    v_dot2c_f32_bf16 v17, v135, v135
    v_dot2c_f32_bf16 v19, s66, v135
    s_waitcnt lgkmcnt(5)
    v_mfma_f32_32x32x16_bf16 v[64:79], v[48:51], v[136:139], v[64:79]
    v_mfma_f32_32x32x16_bf16 v[80:95], v[52:55], v[136:139], v[80:95]
    s_waitcnt lgkmcnt(0)
    s_barrier
    v_mfma_f32_32x32x16_bf16 v[64:79], v[56:59], v[140:143], v[64:79]
    ds_read_b128 v[144:147], v2 offset:24576
    ds_read_b64_tr_b16 v[32:33], v10 offset:24576
    ds_read_b64_tr_b16 v[34:35], v10 offset:25088
    ds_read_b64_tr_b16 v[36:37], v11 offset:24576
    ds_read_b64_tr_b16 v[38:39], v11 offset:25088
    v_mfma_f32_32x32x16_bf16 v[80:95], v[60:63], v[140:143], v[80:95]
    ds_read_b128 v[148:151], v3 offset:24576
    ds_read_b64_tr_b16 v[40:41], v10 offset:26624
    ds_read_b64_tr_b16 v[42:43], v10 offset:27136
    ds_read_b64_tr_b16 v[44:45], v11 offset:26624
    ds_read_b64_tr_b16 v[46:47], v11 offset:27136
    v_dot2c_f32_bf16 v16, v136, v136
    v_dot2c_f32_bf16 v18, s66, v136
    v_dot2c_f32_bf16 v17, v137, v137
    v_dot2c_f32_bf16 v19, s66, v137
    v_dot2c_f32_bf16 v16, v138, v138
    v_dot2c_f32_bf16 v18, s66, v138
    v_dot2c_f32_bf16 v17, v139, v139
    v_dot2c_f32_bf16 v19, s66, v139
    v_dot2c_f32_bf16 v16, v140, v140
    v_dot2c_f32_bf16 v18, s66, v140
    v_dot2c_f32_bf16 v17, v141, v141
    v_dot2c_f32_bf16 v19, s66, v141
    v_dot2c_f32_bf16 v16, v142, v142
    v_dot2c_f32_bf16 v18, s66, v142
    v_dot2c_f32_bf16 v17, v143, v143
    v_dot2c_f32_bf16 v19, s66, v143
    s_waitcnt lgkmcnt(5)
    v_mfma_f32_32x32x16_bf16 v[64:79], v[32:35], v[144:147], v[64:79]
    ds_read_b128 v[152:155], v4 offset:24576
    ds_read_b64_tr_b16 v[48:49], v10 offset:28672
    ds_read_b64_tr_b16 v[50:51], v10 offset:29184
    v_mfma_f32_32x32x16_bf16 v[80:95], v[36:39], v[144:147], v[80:95]
    ds_read_b64_tr_b16 v[52:53], v11 offset:28672
    ds_read_b64_tr_b16 v[54:55], v11 offset:29184
    s_waitcnt lgkmcnt(5)
    v_mfma_f32_32x32x16_bf16 v[64:79], v[40:43], v[148:151], v[64:79]
    ds_read_b128 v[156:159], v5 offset:24576
    ds_read_b64_tr_b16 v[56:57], v10 offset:30720
    ds_read_b64_tr_b16 v[58:59], v10 offset:31232
    v_mfma_f32_32x32x16_bf16 v[80:95], v[44:47], v[148:151], v[80:95]
    ds_read_b64_tr_b16 v[60:61], v11 offset:30720
    ds_read_b64_tr_b16 v[62:63], v11 offset:31232
    v_dot2c_f32_bf16 v16, v144, v144
    v_dot2c_f32_bf16 v18, s66, v144
    v_dot2c_f32_bf16 v17, v145, v145
    v_dot2c_f32_bf16 v19, s66, v145
    v_dot2c_f32_bf16 v16, v146, v146
    v_dot2c_f32_bf16 v18, s66, v146
    v_dot2c_f32_bf16 v17, v147, v147
    v_dot2c_f32_bf16 v19, s66, v147
    v_dot2c_f32_bf16 v16, v148, v148
    v_dot2c_f32_bf16 v18, s66, v148
    v_dot2c_f32_bf16 v17, v149, v149
    v_dot2c_f32_bf16 v19, s66, v149
    v_dot2c_f32_bf16 v16, v150, v150
    v_dot2c_f32_bf16 v18, s66, v150
    v_dot2c_f32_bf16 v17, v151, v151
    v_dot2c_f32_bf16 v19, s66, v151
    s_waitcnt lgkmcnt(5)
    v_mfma_f32_32x32x16_bf16 v[64:79], v[48:51], v[152:155], v[64:79]
    v_mfma_f32_32x32x16_bf16 v[80:95], v[52:55], v[152:155], v[80:95]
    s_waitcnt lgkmcnt(0)
    s_barrier
    v_mfma_f32_32x32x16_bf16 v[64:79], v[56:59], v[156:159], v[64:79]
    ds_read_b128 v[160:163], v2 offset:49152
    ds_read_b64_tr_b16 v[32:33], v10 offset:49152
    ds_read_b64_tr_b16 v[34:35], v10 offset:49664
    ds_read_b64_tr_b16 v[36:37], v11 offset:49152
    ds_read_b64_tr_b16 v[38:39], v11 offset:49664
    v_mfma_f32_32x32x16_bf16 v[80:95], v[60:63], v[156:159], v[80:95]
    ds_read_b128 v[164:167], v3 offset:49152
    ds_read_b64_tr_b16 v[40:41], v10 offset:51200
    ds_read_b64_tr_b16 v[42:43], v10 offset:51712
    ds_read_b64_tr_b16 v[44:45], v11 offset:51200
    ds_read_b64_tr_b16 v[46:47], v11 offset:51712
    v_dot2c_f32_bf16 v16, v152, v152
    v_dot2c_f32_bf16 v18, s66, v152
    v_dot2c_f32_bf16 v17, v153, v153
    v_dot2c_f32_bf16 v19, s66, v153
    v_dot2c_f32_bf16 v16, v154, v154
    v_dot2c_f32_bf16 v18, s66, v154
    v_dot2c_f32_bf16 v17, v155, v155
    v_dot2c_f32_bf16 v19, s66, v155
    v_dot2c_f32_bf16 v16, v156, v156
    v_dot2c_f32_bf16 v18, s66, v156
    v_dot2c_f32_bf16 v17, v157, v157
    v_dot2c_f32_bf16 v19, s66, v157
    v_dot2c_f32_bf16 v16, v158, v158
    v_dot2c_f32_bf16 v18, s66, v158
    v_dot2c_f32_bf16 v17, v159, v159
    v_dot2c_f32_bf16 v19, s66, v159
    s_waitcnt lgkmcnt(5)
    v_mfma_f32_32x32x16_bf16 v[64:79], v[32:35], v[160:163], v[64:79]
    ds_read_b128 v[168:171], v4 offset:49152
    ds_read_b64_tr_b16 v[48:49], v10 offset:53248
    ds_read_b64_tr_b16 v[50:51], v10 offset:53760
    v_mfma_f32_32x32x16_bf16 v[80:95], v[36:39], v[160:163], v[80:95]
    ds_read_b64_tr_b16 v[52:53], v11 offset:53248
    ds_read_b64_tr_b16 v[54:55], v11 offset:53760
    s_waitcnt lgkmcnt(5)
    v_mfma_f32_32x32x16_bf16 v[64:79], v[40:43], v[164:167], v[64:79]
    ds_read_b128 v[172:175], v5 offset:49152
    ds_read_b64_tr_b16 v[56:57], v10 offset:55296
    ds_read_b64_tr_b16 v[58:59], v10 offset:55808
    v_mfma_f32_32x32x16_bf16 v[80:95], v[44:47], v[164:167], v[80:95]
    ds_read_b64_tr_b16 v[60:61], v11 offset:55296
    ds_read_b64_tr_b16 v[62:63], v11 offset:55808
    v_dot2c_f32_bf16 v16, v160, v160
    v_dot2c_f32_bf16 v18, s66, v160
    v_dot2c_f32_bf16 v17, v161, v161
    v_dot2c_f32_bf16 v19, s66, v161
    v_dot2c_f32_bf16 v16, v162, v162
    v_dot2c_f32_bf16 v18, s66, v162
    v_dot2c_f32_bf16 v17, v163, v163
    v_dot2c_f32_bf16 v19, s66, v163
    v_dot2c_f32_bf16 v16, v164, v164
    v_dot2c_f32_bf16 v18, s66, v164
    v_dot2c_f32_bf16 v17, v165, v165
    v_dot2c_f32_bf16 v19, s66, v165
    v_dot2c_f32_bf16 v16, v166, v166
    v_dot2c_f32_bf16 v18, s66, v166
    v_dot2c_f32_bf16 v17, v167, v167
    v_dot2c_f32_bf16 v19, s66, v167
    s_waitcnt lgkmcnt(5)
    v_mfma_f32_32x32x16_bf16 v[64:79], v[48:51], v[168:171], v[64:79]
    v_mfma_f32_32x32x16_bf16 v[80:95], v[52:55], v[168:171], v[80:95]
    s_waitcnt lgkmcnt(0)
    s_barrier
    v_mfma_f32_32x32x16_bf16 v[64:79], v[56:59], v[172:175], v[64:79]
    ds_read_b128 v[176:179], v6 offset:0
    ds_read_b64_tr_b16 v[32:33], v12 offset:0
    ds_read_b64_tr_b16 v[34:35], v12 offset:512
    ds_read_b64_tr_b16 v[36:37], v13 offset:0
    ds_read_b64_tr_b16 v[38:39], v13 offset:512
    v_mfma_f32_32x32x16_bf16 v[80:95], v[60:63], v[172:175], v[80:95]
    ds_read_b128 v[180:183], v7 offset:0
    ds_read_b64_tr_b16 v[40:41], v12 offset:2048
    ds_read_b64_tr_b16 v[42:43], v12 offset:2560
    ds_read_b64_tr_b16 v[44:45], v13 offset:2048
    ds_read_b64_tr_b16 v[46:47], v13 offset:2560
    v_dot2c_f32_bf16 v16, v168, v168
    v_dot2c_f32_bf16 v18, s66, v168
    v_dot2c_f32_bf16 v17, v169, v169
    v_dot2c_f32_bf16 v19, s66, v169
    v_dot2c_f32_bf16 v16, v170, v170
    v_dot2c_f32_bf16 v18, s66, v170
    v_dot2c_f32_bf16 v17, v171, v171
    v_dot2c_f32_bf16 v19, s66, v171
    v_dot2c_f32_bf16 v16, v172, v172
    v_dot2c_f32_bf16 v18, s66, v172
    v_dot2c_f32_bf16 v17, v173, v173
    v_dot2c_f32_bf16 v19, s66, v173
    v_dot2c_f32_bf16 v16, v174, v174
    v_dot2c_f32_bf16 v18, s66, v174
    v_dot2c_f32_bf16 v17, v175, v175
    v_dot2c_f32_bf16 v19, s66, v175
    s_waitcnt lgkmcnt(5)
    v_mfma_f32_32x32x16_bf16 v[64:79], v[32:35], v[176:179], v[64:79]
    ds_read_b128 v[184:187], v8 offset:0
    ds_read_b64_tr_b16 v[48:49], v12 offset:4096
    ds_read_b64_tr_b16 v[50:51], v12 offset:4608
    v_mfma_f32_32x32x16_bf16 v[80:95], v[36:39], v[176:179], v[80:95]
    ds_read_b64_tr_b16 v[52:53], v13 offset:4096
    ds_read_b64_tr_b16 v[54:55], v13 offset:4608
    s_waitcnt lgkmcnt(5)
    v_mfma_f32_32x32x16_bf16 v[64:79], v[40:43], v[180:183], v[64:79]
    ds_read_b128 v[188:191], v9 offset:0
    ds_read_b64_tr_b16 v[56:57], v12 offset:6144
    ds_read_b64_tr_b16 v[58:59], v12 offset:6656
    v_mfma_f32_32x32x16_bf16 v[80:95], v[44:47], v[180:183], v[80:95]
    ds_read_b64_tr_b16 v[60:61], v13 offset:6144
    ds_read_b64_tr_b16 v[62:63], v13 offset:6656
    v_dot2c_f32_bf16 v16, v176, v176
    v_dot2c_f32_bf16 v18, s66, v176
    v_dot2c_f32_bf16 v17, v177, v177
    v_dot2c_f32_bf16 v19, s66, v177
    v_dot2c_f32_bf16 v16, v178, v178
    v_dot2c_f32_bf16 v18, s66, v178
    v_dot2c_f32_bf16 v17, v179, v179
    v_dot2c_f32_bf16 v19, s66, v179
    v_dot2c_f32_bf16 v16, v180, v180
    v_dot2c_f32_bf16 v18, s66, v180
    v_dot2c_f32_bf16 v17, v181, v181
    v_dot2c_f32_bf16 v19, s66, v181
    v_dot2c_f32_bf16 v16, v182, v182
    v_dot2c_f32_bf16 v18, s66, v182
    v_dot2c_f32_bf16 v17, v183, v183
    v_dot2c_f32_bf16 v19, s66, v183
    s_waitcnt lgkmcnt(5)
    v_mfma_f32_32x32x16_bf16 v[64:79], v[48:51], v[184:187], v[64:79]
    v_mfma_f32_32x32x16_bf16 v[80:95], v[52:55], v[184:187], v[80:95]
    s_waitcnt lgkmcnt(0)
    s_barrier
    v_mfma_f32_32x32x16_bf16 v[64:79], v[56:59], v[188:191], v[64:79]
    ds_read_b128 v[192:195], v2 offset:0
    ds_read_b64_tr_b16 v[32:33], v10 offset:0
    ds_read_b64_tr_b16 v[34:35], v10 offset:512
    ds_read_b64_tr_b16 v[36:37], v11 offset:0
    ds_read_b64_tr_b16 v[38:39], v11 offset:512
    v_mfma_f32_32x32x16_bf16 v[80:95], v[60:63], v[188:191], v[80:95]
    ds_read_b128 v[196:199], v3 offset:0
    ds_read_b64_tr_b16 v[40:41], v10 offset:2048
    ds_read_b64_tr_b16 v[42:43], v10 offset:2560
    ds_read_b64_tr_b16 v[44:45], v11 offset:2048
    ds_read_b64_tr_b16 v[46:47], v11 offset:2560
    v_dot2c_f32_bf16 v16, v184, v184
    v_dot2c_f32_bf16 v18, s66, v184
    v_dot2c_f32_bf16 v17, v185, v185
    v_dot2c_f32_bf16 v19, s66, v185
    v_dot2c_f32_bf16 v16, v186, v186
    v_dot2c_f32_bf16 v18, s66, v186
    v_dot2c_f32_bf16 v17, v187, v187
    v_dot2c_f32_bf16 v19, s66, v187
    v_dot2c_f32_bf16 v16, v188, v188
    v_dot2c_f32_bf16 v18, s66, v188
    v_dot2c_f32_bf16 v17, v189, v189
    v_dot2c_f32_bf16 v19, s66, v189
    v_dot2c_f32_bf16 v16, v190, v190
    v_dot2c_f32_bf16 v18, s66, v190
    v_dot2c_f32_bf16 v17, v191, v191
    v_dot2c_f32_bf16 v19, s66, v191
    s_waitcnt lgkmcnt(5)
    v_mfma_f32_32x32x16_bf16 v[64:79], v[32:35], v[192:195], v[64:79]
    ds_read_b128 v[200:203], v4 offset:0
    ds_read_b64_tr_b16 v[48:49], v10 offset:4096
    ds_read_b64_tr_b16 v[50:51], v10 offset:4608
    v_mfma_f32_32x32x16_bf16 v[80:95], v[36:39], v[192:195], v[80:95]
    ds_read_b64_tr_b16 v[52:53], v11 offset:4096
    ds_read_b64_tr_b16 v[54:55], v11 offset:4608
    s_waitcnt lgkmcnt(5)
    v_mfma_f32_32x32x16_bf16 v[64:79], v[40:43], v[196:199], v[64:79]
    ds_read_b128 v[204:207], v5 offset:0
    ds_read_b64_tr_b16 v[56:57], v10 offset:6144
    ds_read_b64_tr_b16 v[58:59], v10 offset:6656
    v_mfma_f32_32x32x16_bf16 v[80:95], v[44:47], v[196:199], v[80:95]
    ds_read_b64_tr_b16 v[60:61], v11 offset:6144
    ds_read_b64_tr_b16 v[62:63], v11 offset:6656
    v_dot2c_f32_bf16 v16, v192, v192
    v_dot2c_f32_bf16 v18, s66, v192
    v_dot2c_f32_bf16 v17, v193, v193
    v_dot2c_f32_bf16 v19, s66, v193
    v_dot2c_f32_bf16 v16, v194, v194
    v_dot2c_f32_bf16 v18, s66, v194
    v_dot2c_f32_bf16 v17, v195, v195
    v_dot2c_f32_bf16 v19, s66, v195
    v_dot2c_f32_bf16 v16, v196, v196
    v_dot2c_f32_bf16 v18, s66, v196
    v_dot2c_f32_bf16 v17, v197, v197
    v_dot2c_f32_bf16 v19, s66, v197
    v_dot2c_f32_bf16 v16, v198, v198
    v_dot2c_f32_bf16 v18, s66, v198
    v_dot2c_f32_bf16 v17, v199, v199
    v_dot2c_f32_bf16 v19, s66, v199
    s_waitcnt lgkmcnt(5)
    v_mfma_f32_32x32x16_bf16 v[64:79], v[48:51], v[200:203], v[64:79]
    v_mfma_f32_32x32x16_bf16 v[80:95], v[52:55], v[200:203], v[80:95]
    s_waitcnt lgkmcnt(0)
    s_barrier
    v_mfma_f32_32x32x16_bf16 v[64:79], v[56:59], v[204:207], v[64:79]
    ds_read_b128 v[208:211], v2 offset:24576
    ds_read_b64_tr_b16 v[32:33], v10 offset:24576
    ds_read_b64_tr_b16 v[34:35], v10 offset:25088
    ds_read_b64_tr_b16 v[36:37], v11 offset:24576
    ds_read_b64_tr_b16 v[38:39], v11 offset:25088
    v_mfma_f32_32x32x16_bf16 v[80:95], v[60:63], v[204:207], v[80:95]
    ds_read_b128 v[212:215], v3 offset:24576
    ds_read_b64_tr_b16 v[40:41], v10 offset:26624
    ds_read_b64_tr_b16 v[42:43], v10 offset:27136
    ds_read_b64_tr_b16 v[44:45], v11 offset:26624
    ds_read_b64_tr_b16 v[46:47], v11 offset:27136
    v_dot2c_f32_bf16 v16, v200, v200
    v_dot2c_f32_bf16 v18, s66, v200
    v_dot2c_f32_bf16 v17, v201, v201
    v_dot2c_f32_bf16 v19, s66, v201
    v_dot2c_f32_bf16 v16, v202, v202
    v_dot2c_f32_bf16 v18, s66, v202
    v_dot2c_f32_bf16 v17, v203, v203
    v_dot2c_f32_bf16 v19, s66, v203
    v_dot2c_f32_bf16 v16, v204, v204
    v_dot2c_f32_bf16 v18, s66, v204
    v_dot2c_f32_bf16 v17, v205, v205
    v_dot2c_f32_bf16 v19, s66, v205
    v_dot2c_f32_bf16 v16, v206, v206
    v_dot2c_f32_bf16 v18, s66, v206
    v_dot2c_f32_bf16 v17, v207, v207
    v_dot2c_f32_bf16 v19, s66, v207
    s_waitcnt lgkmcnt(5)
    v_mfma_f32_32x32x16_bf16 v[64:79], v[32:35], v[208:211], v[64:79]
    ds_read_b128 v[216:219], v4 offset:24576
    ds_read_b64_tr_b16 v[48:49], v10 offset:28672
    ds_read_b64_tr_b16 v[50:51], v10 offset:29184
    v_mfma_f32_32x32x16_bf16 v[80:95], v[36:39], v[208:211], v[80:95]
    ds_read_b64_tr_b16 v[52:53], v11 offset:28672
    ds_read_b64_tr_b16 v[54:55], v11 offset:29184
    s_waitcnt lgkmcnt(5)
    v_mfma_f32_32x32x16_bf16 v[64:79], v[40:43], v[212:215], v[64:79]
    ds_read_b128 v[220:223], v5 offset:24576
    ds_read_b64_tr_b16 v[56:57], v10 offset:30720
    ds_read_b64_tr_b16 v[58:59], v10 offset:31232
    v_mfma_f32_32x32x16_bf16 v[80:95], v[44:47], v[212:215], v[80:95]
    ds_read_b64_tr_b16 v[60:61], v11 offset:30720
    ds_read_b64_tr_b16 v[62:63], v11 offset:31232
    v_dot2c_f32_bf16 v16, v208, v208
    v_dot2c_f32_bf16 v18, s66, v208
    v_dot2c_f32_bf16 v17, v209, v209
    v_dot2c_f32_bf16 v19, s66, v209
    v_dot2c_f32_bf16 v16, v210, v210
    v_dot2c_f32_bf16 v18, s66, v210
    v_dot2c_f32_bf16 v17, v211, v211
    v_dot2c_f32_bf16 v19, s66, v211
    v_dot2c_f32_bf16 v16, v212, v212
    v_dot2c_f32_bf16 v18, s66, v212
    v_dot2c_f32_bf16 v17, v213, v213
    v_dot2c_f32_bf16 v19, s66, v213
    v_dot2c_f32_bf16 v16, v214, v214
    v_dot2c_f32_bf16 v18, s66, v214
    v_dot2c_f32_bf16 v17, v215, v215
    v_dot2c_f32_bf16 v19, s66, v215
    s_waitcnt lgkmcnt(5)
    v_mfma_f32_32x32x16_bf16 v[64:79], v[48:51], v[216:219], v[64:79]
    v_mfma_f32_32x32x16_bf16 v[80:95], v[52:55], v[216:219], v[80:95]
    s_waitcnt lgkmcnt(0)
    s_waitcnt vmcnt(0)
    s_barrier
    v_mfma_f32_32x32x16_bf16 v[64:79], v[56:59], v[220:223], v[64:79]
    ds_read_b128 v[224:227], v2 offset:49152
    ds_read_b64_tr_b16 v[32:33], v10 offset:49152
    ds_read_b64_tr_b16 v[34:35], v10 offset:49664
    ds_read_b64_tr_b16 v[36:37], v11 offset:49152
    ds_read_b64_tr_b16 v[38:39], v11 offset:49664
    v_mfma_f32_32x32x16_bf16 v[80:95], v[60:63], v[220:223], v[80:95]
    ds_read_b128 v[228:231], v3 offset:49152
    ds_read_b64_tr_b16 v[40:41], v10 offset:51200
    ds_read_b64_tr_b16 v[42:43], v10 offset:51712
    ds_read_b64_tr_b16 v[44:45], v11 offset:51200
    ds_read_b64_tr_b16 v[46:47], v11 offset:51712
    v_dot2c_f32_bf16 v16, v216, v216
    v_dot2c_f32_bf16 v18, s66, v216
    v_dot2c_f32_bf16 v17, v217, v217
    v_dot2c_f32_bf16 v19, s66, v217
    v_dot2c_f32_bf16 v16, v218, v218
    v_dot2c_f32_bf16 v18, s66, v218
    v_dot2c_f32_bf16 v17, v219, v219
    v_dot2c_f32_bf16 v19, s66, v219
    v_dot2c_f32_bf16 v16, v220, v220
    v_dot2c_f32_bf16 v18, s66, v220
    v_dot2c_f32_bf16 v17, v221, v221
    v_dot2c_f32_bf16 v19, s66, v221
    v_dot2c_f32_bf16 v16, v222, v222
    v_dot2c_f32_bf16 v18, s66, v222
    v_dot2c_f32_bf16 v17, v223, v223
    v_dot2c_f32_bf16 v19, s66, v223
    s_waitcnt lgkmcnt(5)
    v_mfma_f32_32x32x16_bf16 v[64:79], v[32:35], v[224:227], v[64:79]
    ds_read_b128 v[232:235], v4 offset:49152
    ds_read_b64_tr_b16 v[48:49], v10 offset:53248
    ds_read_b64_tr_b16 v[50:51], v10 offset:53760
    v_mfma_f32_32x32x16_bf16 v[80:95], v[36:39], v[224:227], v[80:95]
    ds_read_b64_tr_b16 v[52:53], v11 offset:53248
    ds_read_b64_tr_b16 v[54:55], v11 offset:53760
    s_waitcnt lgkmcnt(5)
    v_mfma_f32_32x32x16_bf16 v[64:79], v[40:43], v[228:231], v[64:79]
    ds_read_b128 v[236:239], v5 offset:49152
    ds_read_b64_tr_b16 v[56:57], v10 offset:55296
    ds_read_b64_tr_b16 v[58:59], v10 offset:55808
    v_mfma_f32_32x32x16_bf16 v[80:95], v[44:47], v[228:231], v[80:95]
    ds_read_b64_tr_b16 v[60:61], v11 offset:55296
    ds_read_b64_tr_b16 v[62:63], v11 offset:55808
    v_dot2c_f32_bf16 v16, v224, v224
    v_dot2c_f32_bf16 v18, s66, v224
    v_dot2c_f32_bf16 v17, v225, v225
    v_dot2c_f32_bf16 v19, s66, v225
    v_dot2c_f32_bf16 v16, v226, v226
    v_dot2c_f32_bf16 v18, s66, v226
    v_dot2c_f32_bf16 v17, v227, v227
    v_dot2c_f32_bf16 v19, s66, v227
    v_dot2c_f32_bf16 v16, v228, v228
    v_dot2c_f32_bf16 v18, s66, v228
    v_dot2c_f32_bf16 v17, v229, v229
    v_dot2c_f32_bf16 v19, s66, v229
    v_dot2c_f32_bf16 v16, v230, v230
    v_dot2c_f32_bf16 v18, s66, v230
    v_dot2c_f32_bf16 v17, v231, v231
    v_dot2c_f32_bf16 v19, s66, v231
    s_waitcnt lgkmcnt(5)
    v_mfma_f32_32x32x16_bf16 v[64:79], v[48:51], v[232:235], v[64:79]
    v_mfma_f32_32x32x16_bf16 v[80:95], v[52:55], v[232:235], v[80:95]
    s_waitcnt lgkmcnt(0)
    s_barrier
    v_mfma_f32_32x32x16_bf16 v[64:79], v[56:59], v[236:239], v[64:79]
    ds_read_b128 v[240:243], v6 offset:0
    ds_read_b64_tr_b16 v[32:33], v12 offset:0
    ds_read_b64_tr_b16 v[34:35], v12 offset:512
    ds_read_b64_tr_b16 v[36:37], v13 offset:0
    ds_read_b64_tr_b16 v[38:39], v13 offset:512
    v_mfma_f32_32x32x16_bf16 v[80:95], v[60:63], v[236:239], v[80:95]
    ds_read_b128 v[244:247], v7 offset:0
    ds_read_b64_tr_b16 v[40:41], v12 offset:2048
    ds_read_b64_tr_b16 v[42:43], v12 offset:2560
    ds_read_b64_tr_b16 v[44:45], v13 offset:2048
    ds_read_b64_tr_b16 v[46:47], v13 offset:2560
    v_dot2c_f32_bf16 v16, v232, v232
    v_dot2c_f32_bf16 v18, s66, v232
    v_dot2c_f32_bf16 v17, v233, v233
    v_dot2c_f32_bf16 v19, s66, v233
    v_dot2c_f32_bf16 v16, v234, v234
    v_dot2c_f32_bf16 v18, s66, v234
    v_dot2c_f32_bf16 v17, v235, v235
    v_dot2c_f32_bf16 v19, s66, v235
    v_dot2c_f32_bf16 v16, v236, v236
    v_dot2c_f32_bf16 v18, s66, v236
    v_dot2c_f32_bf16 v17, v237, v237
    v_dot2c_f32_bf16 v19, s66, v237
    v_dot2c_f32_bf16 v16, v238, v238
    v_dot2c_f32_bf16 v18, s66, v238
    v_dot2c_f32_bf16 v17, v239, v239
    v_dot2c_f32_bf16 v19, s66, v239
    s_waitcnt lgkmcnt(5)
    v_mfma_f32_32x32x16_bf16 v[64:79], v[32:35], v[240:243], v[64:79]
    ds_read_b128 v[248:251], v8 offset:0
    ds_read_b64_tr_b16 v[48:49], v12 offset:4096
    ds_read_b64_tr_b16 v[50:51], v12 offset:4608
    v_mfma_f32_32x32x16_bf16 v[80:95], v[36:39], v[240:243], v[80:95]
    ds_read_b64_tr_b16 v[52:53], v13 offset:4096
    ds_read_b64_tr_b16 v[54:55], v13 offset:4608
    s_waitcnt lgkmcnt(5)
    v_mfma_f32_32x32x16_bf16 v[64:79], v[40:43], v[244:247], v[64:79]
    ds_read_b128 v[252:255], v9 offset:0
    ds_read_b64_tr_b16 v[56:57], v12 offset:6144
    ds_read_b64_tr_b16 v[58:59], v12 offset:6656
    v_mfma_f32_32x32x16_bf16 v[80:95], v[44:47], v[244:247], v[80:95]
    ds_read_b64_tr_b16 v[60:61], v13 offset:6144
    ds_read_b64_tr_b16 v[62:63], v13 offset:6656
    v_dot2c_f32_bf16 v16, v240, v240
    v_dot2c_f32_bf16 v18, s66, v240
    v_dot2c_f32_bf16 v17, v241, v241
    v_dot2c_f32_bf16 v19, s66, v241
    v_dot2c_f32_bf16 v16, v242, v242
    v_dot2c_f32_bf16 v18, s66, v242
    v_dot2c_f32_bf16 v17, v243, v243
    v_dot2c_f32_bf16 v19, s66, v243
    v_dot2c_f32_bf16 v16, v244, v244
    v_dot2c_f32_bf16 v18, s66, v244
    v_dot2c_f32_bf16 v17, v245, v245
    v_dot2c_f32_bf16 v19, s66, v245
    v_dot2c_f32_bf16 v16, v246, v246
    v_dot2c_f32_bf16 v18, s66, v246
    v_dot2c_f32_bf16 v17, v247, v247
    v_dot2c_f32_bf16 v19, s66, v247
    s_waitcnt lgkmcnt(5)
    v_mfma_f32_32x32x16_bf16 v[64:79], v[48:51], v[248:251], v[64:79]
    v_mfma_f32_32x32x16_bf16 v[80:95], v[52:55], v[248:251], v[80:95]
    s_waitcnt lgkmcnt(0)
    s_barrier
    v_mfma_f32_32x32x16_bf16 v[64:79], v[56:59], v[252:255], v[64:79]
    ds_read_b64_tr_b16 v[32:33], v14 offset:0
    ds_read_b64_tr_b16 v[34:35], v14 offset:512
    ds_read_b64_tr_b16 v[36:37], v14 offset:2048
    v_mfma_f32_32x32x16_bf16 v[80:95], v[60:63], v[252:255], v[80:95]
    ds_read_b64_tr_b16 v[38:39], v14 offset:2560
    ds_read_b64_tr_b16 v[40:41], v14 offset:4096
    ds_read_b64_tr_b16 v[42:43], v14 offset:4608
    v_dot2c_f32_bf16 v16, v248, v248
    v_dot2c_f32_bf16 v18, s66, v248
    v_dot2c_f32_bf16 v17, v249, v249
    v_dot2c_f32_bf16 v19, s66, v249
    v_dot2c_f32_bf16 v16, v250, v250
    v_dot2c_f32_bf16 v18, s66, v250
    v_dot2c_f32_bf16 v17, v251, v251
    v_dot2c_f32_bf16 v19, s66, v251
    v_dot2c_f32_bf16 v16, v252, v252
    v_dot2c_f32_bf16 v18, s66, v252
    v_dot2c_f32_bf16 v17, v253, v253
    v_dot2c_f32_bf16 v19, s66, v253
    v_dot2c_f32_bf16 v16, v254, v254
    v_dot2c_f32_bf16 v18, s66, v254
    v_dot2c_f32_bf16 v17, v255, v255
    v_dot2c_f32_bf16 v19, s66, v255
    s_waitcnt lgkmcnt(4)
    v_mfma_f32_32x32x16_bf16 v[96:111], v[32:35], v[128:131], 0
    ds_read_b64_tr_b16 v[44:45], v14 offset:6144
    ds_read_b64_tr_b16 v[46:47], v14 offset:6656
    s_nop 0
    v_add_f32 v16, v16, v17
    v_add_f32 v18, v18, v19
    v_mov_b32 v17, v16
    s_waitcnt lgkmcnt(4)
    v_mfma_f32_32x32x16_bf16 v[96:111], v[36:39], v[132:135], v[96:111]
    ds_read_b64_tr_b16 v[32:33], v14 offset:8192
    ds_read_b64_tr_b16 v[34:35], v14 offset:8704
    v_mov_b32 v19, v18
    s_nop 1
    v_permlane32_swap_b32 v16, v17
    v_permlane32_swap_b32 v18, v19
    s_waitcnt lgkmcnt(4)
    v_mfma_f32_32x32x16_bf16 v[96:111], v[40:43], v[136:139], v[96:111]
    ds_read_b64_tr_b16 v[36:37], v14 offset:10240
    ds_read_b64_tr_b16 v[38:39], v14 offset:10752
    v_add_f32 v16, v16, v17
    v_add_f32 v18, v18, v19
    v_mul_f32 v18, 0x3b000000, v18
    v_mul_f32 v16, 0x3b000000, v16
    s_waitcnt lgkmcnt(4)
    v_mfma_f32_32x32x16_bf16 v[96:111], v[44:47], v[140:143], v[96:111]
    ds_read_b64_tr_b16 v[40:41], v14 offset:12288
    ds_read_b64_tr_b16 v[42:43], v14 offset:12800
    v_fma_f32 v16, -v18, v18, v16
    v_max_f32 v16, 0, v16
    v_cvt_pk_bf16_f32 v31, v16, v16
    v_and_b32 v31, 0xffff0000, v31
    s_waitcnt lgkmcnt(4)
    v_mfma_f32_32x32x16_bf16 v[96:111], v[32:35], v[144:147], v[96:111]
    ds_read_b64_tr_b16 v[44:45], v14 offset:14336
    ds_read_b64_tr_b16 v[46:47], v14 offset:14848
    v_add_f32 v31, 0x3727c5ac, v31
    v_cvt_pk_bf16_f32 v31, v31, v31
    v_and_b32 v31, 0xffff0000, v31
    v_sqrt_f32 v31, v31
    s_barrier
    s_waitcnt lgkmcnt(4)
    v_mfma_f32_32x32x16_bf16 v[96:111], v[36:39], v[148:151], v[96:111]
    ds_read_b64_tr_b16 v[32:33], v14 offset:16384
    ds_read_b64_tr_b16 v[34:35], v14 offset:16896
    v_cvt_pk_bf16_f32 v24, -v18, -v18
    v_cvt_pk_bf16_f32 v25, -v18, v31
    v_and_b32 v24, v28, v24
    v_and_b32 v22, 0xffff0000, v25
    s_waitcnt lgkmcnt(4)
    v_mfma_f32_32x32x16_bf16 v[96:111], v[40:43], v[152:155], v[96:111]
    ds_read_b64_tr_b16 v[36:37], v14 offset:18432
    ds_read_b64_tr_b16 v[38:39], v14 offset:18944
    v_and_b32 v25, v28, v25
    v_mov_b32 v26, v24
    v_rcp_f32 v31, v22
    v_mov_b32 v27, v25
    s_waitcnt lgkmcnt(4)
    v_mfma_f32_32x32x16_bf16 v[96:111], v[44:47], v[156:159], v[96:111]
    ds_read_b64_tr_b16 v[40:41], v14 offset:20480
    ds_read_b64_tr_b16 v[42:43], v14 offset:20992
    v_mov_b32 v23, v22
    v_mul_f32 v2, 0xc0135761, v31
    v_mul_f32 v17, v31, v31
    v_mul_f32 v17, 0x3d372713, v17
    s_waitcnt lgkmcnt(4)
    v_mfma_f32_32x32x16_bf16 v[96:111], v[32:35], v[160:163], v[96:111]
    ds_read_b64_tr_b16 v[44:45], v14 offset:22528
    ds_read_b64_tr_b16 v[46:47], v14 offset:23040
    v_mov_b32 v3, v2
    v_mul_f32 v20, v2, v17
    v_mul_f32 v21, v2, v17
    v_mov_b32 v4, 0
    s_barrier
    s_waitcnt lgkmcnt(4)
    v_mfma_f32_32x32x16_bf16 v[96:111], v[36:39], v[164:167], v[96:111]
    ds_read_b64_tr_b16 v[32:33], v14 offset:24576
    ds_read_b64_tr_b16 v[34:35], v14 offset:25088
    ds_read2_b64 v[112:115], v29 offset0:0 offset1:128
    ds_read2_b64 v[116:119], v29 offset0:32 offset1:160
    v_mov_b32 v5, 1
    v_mul_u32_u24 v7, 128, v1
    s_waitcnt lgkmcnt(6)
    v_mfma_f32_32x32x16_bf16 v[96:111], v[40:43], v[168:171], v[96:111]
    ds_read_b64_tr_b16 v[36:37], v14 offset:26624
    ds_read_b64_tr_b16 v[38:39], v14 offset:27136
    ds_read2_b64 v[120:123], v29 offset0:64 offset1:192
    ds_read2_b64 v[56:59], v29 offset0:96 offset1:224
    s_waitcnt lgkmcnt(8)
    v_mfma_f32_32x32x16_bf16 v[96:111], v[44:47], v[172:175], v[96:111]
    ds_read_b64_tr_b16 v[40:41], v14 offset:28672
    ds_read_b64_tr_b16 v[42:43], v14 offset:29184
    s_waitcnt lgkmcnt(8)
    v_mfma_f32_32x32x16_bf16 v[96:111], v[32:35], v[176:179], v[96:111]
    ds_read_b64_tr_b16 v[44:45], v14 offset:30720
    ds_read_b64_tr_b16 v[46:47], v14 offset:31232
    s_waitcnt lgkmcnt(4)
    v_and_b32 v16, v113, v115
    v_bitop3_b32 v16, v16, v117, v119 bitop3:0x80
    v_bitop3_b32 v16, v16, v121, v123 bitop3:0x80
    v_mfma_f32_32x32x16_bf16 v[96:111], v[36:39], v[180:183], v[96:111]
    ds_read_b64_tr_b16 v[32:33], v14 offset:32768
    ds_read_b64_tr_b16 v[34:35], v14 offset:33280
    v_bitop3_b32 v16, v16, v57, v59 bitop3:0x80
    v_and_b32 v16, 1, v16
    v_cmp_eq_u32 vcc, 0, v16
    s_mov_b32 s63, 0
    s_cmp_eq_u64 vcc, 0
    s_cbranch_scc1 L_augok
    s_lshl_b32 s59, s56, 11
    s_add_u32 s59, s59, 8400896
L_augretry:
    buffer_load_dwordx2 v[112:113], v29, s[36:39], s59 offen offset:0 sc1
    buffer_load_dwordx2 v[114:115], v29, s[36:39], s59 offen offset:1024 sc1
    buffer_load_dwordx2 v[116:117], v29, s[36:39], s59 offen offset:256 sc1
    buffer_load_dwordx2 v[118:119], v29, s[36:39], s59 offen offset:1280 sc1
    buffer_load_dwordx2 v[120:121], v29, s[36:39], s59 offen offset:512 sc1
    buffer_load_dwordx2 v[122:123], v29, s[36:39], s59 offen offset:1536 sc1
    buffer_load_dwordx2 v[56:57], v29, s[36:39], s59 offen offset:768 sc1
    buffer_load_dwordx2 v[58:59], v29, s[36:39], s59 offen offset:1792 sc1
    s_waitcnt vmcnt(0)
    v_and_b32 v16, v113, v115
    v_bitop3_b32 v16, v16, v117, v119 bitop3:0x80
    v_bitop3_b32 v16, v16, v121, v123 bitop3:0x80
    v_bitop3_b32 v16, v16, v57, v59 bitop3:0x80
    v_and_b32 v16, 1, v16
    v_cmp_eq_u32 vcc, 0, v16
    s_add_u32 s63, s63, 1
    s_cmp_eq_u64 vcc, 0
    s_cbranch_scc1 L_augok
    s_sleep 4
    s_cmp_lt_u32 s63, 0x100000
    s_cbranch_scc1 L_augretry
    s_endpgm
L_augok:
    v_mfma_f32_32x32x16_bf16 v[64:79], v[112:115], v[24:27], v[64:79]
    v_mfma_f32_32x32x16_bf16 v[80:95], v[116:119], v[24:27], v[80:95]
    v_mfma_f32_32x32x16_bf16 v[96:111], v[120:123], v[24:27], v[96:111]
    v_mfma_f32_32x32x16_bf16 v[112:127], v[56:59], v[24:27], 0
    s_nop 11
    v_pk_mul_f32 v[48:49], v[64:65], v[64:65]
    v_pk_mul_f32 v[50:51], v[66:67], v[66:67]
    v_pk_mul_f32 v[52:53], v[68:69], v[68:69]
    v_pk_mul_f32 v[54:55], v[70:71], v[70:71]
    v_pk_fma_f32 v[48:49], v[48:49], v[20:21], v[2:3]
    v_pk_fma_f32 v[50:51], v[50:51], v[20:21], v[2:3]
    v_pk_fma_f32 v[52:53], v[52:53], v[20:21], v[2:3]
    v_pk_fma_f32 v[54:55], v[54:55], v[20:21], v[2:3]
    v_pk_mul_f32 v[48:49], v[64:65], v[48:49]
    v_pk_mul_f32 v[50:51], v[66:67], v[50:51]
    v_pk_mul_f32 v[52:53], v[68:69], v[52:53]
    v_pk_mul_f32 v[54:55], v[70:71], v[54:55]
    v_exp_f32 v48, v48
    v_exp_f32 v49, v49
    v_exp_f32 v50, v50
    v_exp_f32 v51, v51
    v_exp_f32 v52, v52
    v_exp_f32 v53, v53
    v_exp_f32 v54, v54
    v_exp_f32 v55, v55
    v_pk_fma_f32 v[48:49], v[48:49], v[22:23], v[22:23]
    v_pk_fma_f32 v[50:51], v[50:51], v[22:23], v[22:23]
    v_pk_fma_f32 v[52:53], v[52:53], v[22:23], v[22:23]
    v_pk_fma_f32 v[54:55], v[54:55], v[22:23], v[22:23]
    v_rcp_f32 v48, v48
    v_rcp_f32 v49, v49
    v_rcp_f32 v50, v50
    v_rcp_f32 v51, v51
    v_rcp_f32 v52, v52
    v_rcp_f32 v53, v53
    v_rcp_f32 v54, v54
    v_rcp_f32 v55, v55
    v_pk_mul_f32 v[48:49], v[64:65], v[48:49]
    v_pk_mul_f32 v[50:51], v[66:67], v[50:51]
    v_pk_mul_f32 v[52:53], v[68:69], v[52:53]
    v_pk_mul_f32 v[54:55], v[70:71], v[54:55]
    v_cvt_pk_bf16_f32 v64, v48, v49
    v_cvt_pk_bf16_f32 v65, v50, v51
    v_cvt_pk_bf16_f32 v66, v52, v53
    v_cvt_pk_bf16_f32 v67, v54, v55
    s_add_u32 s94, s64, 0
    buffer_store_dwordx4 v[64:67], v30, s[36:39], s94 offen offset:0 sc1
    v_pk_mul_f32 v[48:49], v[72:73], v[72:73]
    v_pk_mul_f32 v[50:51], v[74:75], v[74:75]
    v_pk_mul_f32 v[52:53], v[76:77], v[76:77]
    v_pk_mul_f32 v[54:55], v[78:79], v[78:79]
    v_pk_fma_f32 v[48:49], v[48:49], v[20:21], v[2:3]
    v_pk_fma_f32 v[50:51], v[50:51], v[20:21], v[2:3]
    v_pk_fma_f32 v[52:53], v[52:53], v[20:21], v[2:3]
    v_pk_fma_f32 v[54:55], v[54:55], v[20:21], v[2:3]
    v_pk_mul_f32 v[48:49], v[72:73], v[48:49]
    v_pk_mul_f32 v[50:51], v[74:75], v[50:51]
    v_pk_mul_f32 v[52:53], v[76:77], v[52:53]
    v_pk_mul_f32 v[54:55], v[78:79], v[54:55]
    v_exp_f32 v48, v48
    v_exp_f32 v49, v49
    v_exp_f32 v50, v50
    v_exp_f32 v51, v51
    v_exp_f32 v52, v52
    v_exp_f32 v53, v53
    v_exp_f32 v54, v54
    v_exp_f32 v55, v55
    v_pk_fma_f32 v[48:49], v[48:49], v[22:23], v[22:23]
    v_pk_fma_f32 v[50:51], v[50:51], v[22:23], v[22:23]
    v_pk_fma_f32 v[52:53], v[52:53], v[22:23], v[22:23]
    v_pk_fma_f32 v[54:55], v[54:55], v[22:23], v[22:23]
    v_rcp_f32 v48, v48
    v_rcp_f32 v49, v49
    v_rcp_f32 v50, v50
    v_rcp_f32 v51, v51
    v_rcp_f32 v52, v52
    v_rcp_f32 v53, v53
    v_rcp_f32 v54, v54
    v_rcp_f32 v55, v55
    v_pk_mul_f32 v[48:49], v[72:73], v[48:49]
    v_pk_mul_f32 v[50:51], v[74:75], v[50:51]
    v_pk_mul_f32 v[52:53], v[76:77], v[52:53]
    v_pk_mul_f32 v[54:55], v[78:79], v[54:55]
    v_cvt_pk_bf16_f32 v72, v48, v49
    v_cvt_pk_bf16_f32 v73, v50, v51
    v_cvt_pk_bf16_f32 v74, v52, v53
    v_cvt_pk_bf16_f32 v75, v54, v55
    buffer_store_dwordx4 v[72:75], v30, s[36:39], s94 offen offset:1024 sc1
    s_waitcnt lgkmcnt(4)
    v_mfma_f32_32x32x16_bf16 v[96:111], v[40:43], v[184:187], v[96:111]
    ds_read_b64_tr_b16 v[36:37], v14 offset:34816
    ds_read_b64_tr_b16 v[38:39], v14 offset:35328
    v_mul_f32 v48, v80, v80
    v_mul_f32 v49, v81, v81
    v_mul_f32 v50, v82, v82
    v_mul_f32 v51, v83, v83
    v_mul_f32 v52, v84, v84
    s_waitcnt lgkmcnt(4)
    v_mfma_f32_32x32x16_bf16 v[96:111], v[44:47], v[188:191], v[96:111]
    ds_read_b64_tr_b16 v[40:41], v14 offset:36864
    ds_read_b64_tr_b16 v[42:43], v14 offset:37376
    v_mul_f32 v53, v85, v85
    v_mul_f32 v54, v86, v86
    v_mul_f32 v55, v87, v87
    v_fma_f32 v48, v48, v20, v2
    v_fma_f32 v49, v49, v20, v2
    s_waitcnt lgkmcnt(4)
    v_mfma_f32_32x32x16_bf16 v[96:111], v[32:35], v[192:195], v[96:111]
    ds_read_b64_tr_b16 v[44:45], v14 offset:38912
    ds_read_b64_tr_b16 v[46:47], v14 offset:39424
    v_fma_f32 v50, v50, v20, v2
    v_fma_f32 v51, v51, v20, v2
    v_fma_f32 v52, v52, v20, v2
    v_fma_f32 v53, v53, v20, v2
    v_fma_f32 v54, v54, v20, v2
    s_waitcnt lgkmcnt(4)
    v_mfma_f32_32x32x16_bf16 v[96:111], v[36:39], v[196:199], v[96:111]
    ds_read_b64_tr_b16 v[32:33], v14 offset:40960
    ds_read_b64_tr_b16 v[34:35], v14 offset:41472
    v_fma_f32 v55, v55, v20, v2
    v_mul_f32 v48, v80, v48
    v_mul_f32 v49, v81, v49
    v_mul_f32 v50, v82, v50
    v_mul_f32 v51, v83, v51
    s_waitcnt lgkmcnt(4)
    v_mfma_f32_32x32x16_bf16 v[96:111], v[40:43], v[200:203], v[96:111]
    ds_read_b64_tr_b16 v[36:37], v14 offset:43008
    ds_read_b64_tr_b16 v[38:39], v14 offset:43520
    v_mul_f32 v52, v84, v52
    v_mul_f32 v53, v85, v53
    v_mul_f32 v54, v86, v54
    v_mul_f32 v55, v87, v55
    v_exp_f32 v48, v48
    s_waitcnt lgkmcnt(4)
    v_mfma_f32_32x32x16_bf16 v[96:111], v[44:47], v[204:207], v[96:111]
    ds_read_b64_tr_b16 v[40:41], v14 offset:45056
    ds_read_b64_tr_b16 v[42:43], v14 offset:45568
    v_exp_f32 v49, v49
    v_exp_f32 v50, v50
    v_fma_f32 v48, v48, v22, v22
    v_exp_f32 v51, v51
    v_fma_f32 v49, v49, v22, v22
    s_waitcnt lgkmcnt(4)
    v_mfma_f32_32x32x16_bf16 v[96:111], v[32:35], v[208:211], v[96:111]
    ds_read_b64_tr_b16 v[44:45], v14 offset:47104
    ds_read_b64_tr_b16 v[46:47], v14 offset:47616
    v_exp_f32 v52, v52
    v_fma_f32 v50, v50, v22, v22
    v_exp_f32 v53, v53
    v_fma_f32 v51, v51, v22, v22
    v_exp_f32 v54, v54
    s_waitcnt lgkmcnt(4)
    v_mfma_f32_32x32x16_bf16 v[96:111], v[36:39], v[212:215], v[96:111]
    ds_read_b64_tr_b16 v[32:33], v14 offset:49152
    ds_read_b64_tr_b16 v[34:35], v14 offset:49664
    v_fma_f32 v52, v52, v22, v22
    v_exp_f32 v55, v55
    v_fma_f32 v53, v53, v22, v22
    v_rcp_f32 v48, v48
    v_fma_f32 v54, v54, v22, v22
    s_waitcnt lgkmcnt(4)
    v_mfma_f32_32x32x16_bf16 v[96:111], v[40:43], v[216:219], v[96:111]
    ds_read_b64_tr_b16 v[36:37], v14 offset:51200
    ds_read_b64_tr_b16 v[38:39], v14 offset:51712
    v_rcp_f32 v49, v49
    v_fma_f32 v55, v55, v22, v22
    v_rcp_f32 v50, v50
    v_mul_f32 v48, v80, v48
    v_rcp_f32 v51, v51
    s_waitcnt lgkmcnt(4)
    v_mfma_f32_32x32x16_bf16 v[96:111], v[44:47], v[220:223], v[96:111]
    ds_read_b64_tr_b16 v[40:41], v14 offset:53248
    ds_read_b64_tr_b16 v[42:43], v14 offset:53760
    v_mul_f32 v49, v81, v49
    v_rcp_f32 v52, v52
    v_mul_f32 v50, v82, v50
    v_rcp_f32 v53, v53
    v_mul_f32 v51, v83, v51
    s_waitcnt lgkmcnt(4)
    v_mfma_f32_32x32x16_bf16 v[96:111], v[32:35], v[224:227], v[96:111]
    ds_read_b64_tr_b16 v[44:45], v14 offset:55296
    ds_read_b64_tr_b16 v[46:47], v14 offset:55808
    v_rcp_f32 v54, v54
    v_mul_f32 v52, v84, v52
    v_rcp_f32 v55, v55
    v_mul_f32 v53, v85, v53
    v_cvt_pk_bf16_f32 v80, v48, v49
    s_waitcnt lgkmcnt(4)
    v_mfma_f32_32x32x16_bf16 v[96:111], v[36:39], v[228:231], v[96:111]
    ds_read_b64_tr_b16 v[32:33], v14 offset:57344
    ds_read_b64_tr_b16 v[34:35], v14 offset:57856
    v_mul_f32 v54, v86, v54
    v_cvt_pk_bf16_f32 v81, v50, v51
    v_mul_f32 v55, v87, v55
    v_cvt_pk_bf16_f32 v82, v52, v53
    v_cvt_pk_bf16_f32 v83, v54, v55
    s_add_u32 s94, s64, 28672
    buffer_store_dwordx4 v[80:83], v30, s[36:39], s94 offen offset:0 sc1
    s_waitcnt lgkmcnt(4)
    v_mfma_f32_32x32x16_bf16 v[96:111], v[40:43], v[232:235], v[96:111]
    ds_read_b64_tr_b16 v[36:37], v14 offset:59392
    ds_read_b64_tr_b16 v[38:39], v14 offset:59904
    v_mul_f32 v48, v88, v88
    v_mul_f32 v49, v89, v89
    v_mul_f32 v50, v90, v90
    v_mul_f32 v51, v91, v91
    s_waitcnt lgkmcnt(4)
    v_mfma_f32_32x32x16_bf16 v[96:111], v[44:47], v[236:239], v[96:111]
    ds_read_b64_tr_b16 v[40:41], v14 offset:61440
    ds_read_b64_tr_b16 v[42:43], v14 offset:61952
    v_mul_f32 v52, v92, v92
    v_mul_f32 v53, v93, v93
    v_mul_f32 v54, v94, v94
    v_mul_f32 v55, v95, v95
    v_fma_f32 v48, v48, v20, v2
    s_waitcnt lgkmcnt(4)
    v_mfma_f32_32x32x16_bf16 v[96:111], v[32:35], v[240:243], v[96:111]
    ds_read_b64_tr_b16 v[44:45], v14 offset:63488
    ds_read_b64_tr_b16 v[46:47], v14 offset:64000
    v_fma_f32 v49, v49, v20, v2
    v_fma_f32 v50, v50, v20, v2
    v_fma_f32 v51, v51, v20, v2
    v_fma_f32 v52, v52, v20, v2
    v_fma_f32 v53, v53, v20, v2
    s_waitcnt lgkmcnt(4)
    v_mfma_f32_32x32x16_bf16 v[96:111], v[36:39], v[244:247], v[96:111]
    ds_read_b64_tr_b16 v[32:33], v15 offset:0
    ds_read_b64_tr_b16 v[34:35], v15 offset:512
    v_fma_f32 v54, v54, v20, v2
    v_fma_f32 v55, v55, v20, v2
    v_mul_f32 v48, v88, v48
    v_mul_f32 v49, v89, v49
    s_waitcnt lgkmcnt(4)
    v_mfma_f32_32x32x16_bf16 v[96:111], v[40:43], v[248:251], v[96:111]
    ds_read_b64_tr_b16 v[36:37], v15 offset:2048
    ds_read_b64_tr_b16 v[38:39], v15 offset:2560
    v_mul_f32 v50, v90, v50
    v_mul_f32 v51, v91, v51
    v_mul_f32 v52, v92, v52
    v_mul_f32 v53, v93, v53
    v_mul_f32 v54, v94, v54
    s_waitcnt lgkmcnt(4)
    v_mfma_f32_32x32x16_bf16 v[96:111], v[44:47], v[252:255], v[96:111]
    ds_read_b64_tr_b16 v[40:41], v15 offset:4096
    ds_read_b64_tr_b16 v[42:43], v15 offset:4608
    v_mul_f32 v55, v95, v55
    v_exp_f32 v48, v48
    v_exp_f32 v49, v49
    v_exp_f32 v50, v50
    v_fma_f32 v48, v48, v22, v22
    s_waitcnt lgkmcnt(4)
    v_mfma_f32_32x32x16_bf16 v[112:127], v[32:35], v[128:131], v[112:127]
    ds_read_b64_tr_b16 v[44:45], v15 offset:6144
    ds_read_b64_tr_b16 v[46:47], v15 offset:6656
    v_exp_f32 v51, v51
    v_fma_f32 v49, v49, v22, v22
    v_exp_f32 v52, v52
    v_fma_f32 v50, v50, v22, v22
    s_waitcnt lgkmcnt(4)
    v_mfma_f32_32x32x16_bf16 v[112:127], v[36:39], v[132:135], v[112:127]
    ds_read_b64_tr_b16 v[32:33], v15 offset:8192
    ds_read_b64_tr_b16 v[34:35], v15 offset:8704
    v_exp_f32 v53, v53
    v_fma_f32 v51, v51, v22, v22
    v_exp_f32 v54, v54
    v_fma_f32 v52, v52, v22, v22
    v_exp_f32 v55, v55
    s_waitcnt lgkmcnt(4)
    v_mfma_f32_32x32x16_bf16 v[112:127], v[40:43], v[136:139], v[112:127]
    ds_read_b64_tr_b16 v[36:37], v15 offset:10240
    ds_read_b64_tr_b16 v[38:39], v15 offset:10752
    v_fma_f32 v53, v53, v22, v22
    v_rcp_f32 v48, v48
    v_fma_f32 v54, v54, v22, v22
    v_rcp_f32 v49, v49
    v_fma_f32 v55, v55, v22, v22
    s_waitcnt lgkmcnt(4)
    v_mfma_f32_32x32x16_bf16 v[112:127], v[44:47], v[140:143], v[112:127]
    ds_read_b64_tr_b16 v[40:41], v15 offset:12288
    ds_read_b64_tr_b16 v[42:43], v15 offset:12800
    v_rcp_f32 v50, v50
    v_mul_f32 v48, v88, v48
    v_rcp_f32 v51, v51
    v_mul_f32 v49, v89, v49
    s_waitcnt lgkmcnt(4)
    v_mfma_f32_32x32x16_bf16 v[112:127], v[32:35], v[144:147], v[112:127]
    ds_read_b64_tr_b16 v[44:45], v15 offset:14336
    ds_read_b64_tr_b16 v[46:47], v15 offset:14848
    v_rcp_f32 v52, v52
    v_mul_f32 v50, v90, v50
    v_rcp_f32 v53, v53
    v_mul_f32 v51, v91, v51
    v_rcp_f32 v54, v54
    s_waitcnt vmcnt(1)
    v_mov_b32 v6, 1
    s_mov_b32 exec_lo, s84
    s_mov_b32 exec_hi, 0
    buffer_atomic_add v6, v7, s[36:39], s68 offen sc1
    s_mov_b64 exec, -1
    s_waitcnt lgkmcnt(4)
    v_mfma_f32_32x32x16_bf16 v[112:127], v[36:39], v[148:151], v[112:127]
    ds_read_b64_tr_b16 v[32:33], v15 offset:16384
    ds_read_b64_tr_b16 v[34:35], v15 offset:16896
    v_mul_f32 v52, v92, v52
    v_rcp_f32 v55, v55
    v_mul_f32 v53, v93, v53
    v_cvt_pk_bf16_f32 v88, v48, v49
    v_mul_f32 v54, v94, v54
    s_waitcnt lgkmcnt(4)
    v_mfma_f32_32x32x16_bf16 v[112:127], v[40:43], v[152:155], v[112:127]
    ds_read_b64_tr_b16 v[36:37], v15 offset:18432
    ds_read_b64_tr_b16 v[38:39], v15 offset:18944
    v_cvt_pk_bf16_f32 v89, v50, v51
    v_mul_f32 v55, v95, v55
    v_cvt_pk_bf16_f32 v90, v52, v53
    v_cvt_pk_bf16_f32 v91, v54, v55
    buffer_store_dwordx4 v[88:91], v30, s[36:39], s94 offen offset:1024 sc1
    s_waitcnt lgkmcnt(4)
    v_mfma_f32_32x32x16_bf16 v[112:127], v[44:47], v[156:159], v[112:127]
    ds_read_b64_tr_b16 v[40:41], v15 offset:20480
    ds_read_b64_tr_b16 v[42:43], v15 offset:20992
    v_mul_f32 v48, v96, v96
    v_mul_f32 v49, v97, v97
    v_mul_f32 v50, v98, v98
    v_mul_f32 v51, v99, v99
    v_mul_f32 v52, v100, v100
    s_waitcnt lgkmcnt(4)
    v_mfma_f32_32x32x16_bf16 v[112:127], v[32:35], v[160:163], v[112:127]
    ds_read_b64_tr_b16 v[44:45], v15 offset:22528
    ds_read_b64_tr_b16 v[46:47], v15 offset:23040
    v_mul_f32 v53, v101, v101
    v_mul_f32 v54, v102, v102
    v_mul_f32 v55, v103, v103
    v_fma_f32 v48, v48, v20, v2
    v_fma_f32 v49, v49, v20, v2
    v_fma_f32 v50, v50, v20, v2
    s_waitcnt lgkmcnt(4)
    v_mfma_f32_32x32x16_bf16 v[112:127], v[36:39], v[164:167], v[112:127]
    ds_read_b64_tr_b16 v[32:33], v15 offset:24576
    ds_read_b64_tr_b16 v[34:35], v15 offset:25088
    v_fma_f32 v51, v51, v20, v2
    v_fma_f32 v52, v52, v20, v2
    v_fma_f32 v53, v53, v20, v2
    v_fma_f32 v54, v54, v20, v2
    v_fma_f32 v55, v55, v20, v2
    s_waitcnt lgkmcnt(4)
    v_mfma_f32_32x32x16_bf16 v[112:127], v[40:43], v[168:171], v[112:127]
    ds_read_b64_tr_b16 v[36:37], v15 offset:26624
    ds_read_b64_tr_b16 v[38:39], v15 offset:27136
    v_mul_f32 v48, v96, v48
    v_mul_f32 v49, v97, v49
    v_mul_f32 v50, v98, v50
    v_mul_f32 v51, v99, v51
    v_mul_f32 v52, v100, v52
    v_mul_f32 v53, v101, v53
    s_waitcnt lgkmcnt(4)
    v_mfma_f32_32x32x16_bf16 v[112:127], v[44:47], v[172:175], v[112:127]
    ds_read_b64_tr_b16 v[40:41], v15 offset:28672
    ds_read_b64_tr_b16 v[42:43], v15 offset:29184
    v_mul_f32 v54, v102, v54
    v_mul_f32 v55, v103, v55
    v_exp_f32 v48, v48
    v_exp_f32 v49, v49
    v_exp_f32 v50, v50
    s_waitcnt lgkmcnt(4)
    v_mfma_f32_32x32x16_bf16 v[112:127], v[32:35], v[176:179], v[112:127]
    ds_read_b64_tr_b16 v[44:45], v15 offset:30720
    ds_read_b64_tr_b16 v[46:47], v15 offset:31232
    v_fma_f32 v48, v48, v22, v22
    v_exp_f32 v51, v51
    v_fma_f32 v49, v49, v22, v22
    v_exp_f32 v52, v52
    v_fma_f32 v50, v50, v22, v22
    v_exp_f32 v53, v53
    s_waitcnt lgkmcnt(4)
    v_mfma_f32_32x32x16_bf16 v[112:127], v[36:39], v[180:183], v[112:127]
    ds_read_b64_tr_b16 v[32:33], v15 offset:32768
    ds_read_b64_tr_b16 v[34:35], v15 offset:33280
    v_fma_f32 v51, v51, v22, v22
    v_exp_f32 v54, v54
    v_fma_f32 v52, v52, v22, v22
    v_exp_f32 v55, v55
    v_fma_f32 v53, v53, v22, v22
    s_waitcnt lgkmcnt(4)
    v_mfma_f32_32x32x16_bf16 v[112:127], v[40:43], v[184:187], v[112:127]
    ds_read_b64_tr_b16 v[36:37], v15 offset:34816
    ds_read_b64_tr_b16 v[38:39], v15 offset:35328
    v_rcp_f32 v48, v48
    v_fma_f32 v54, v54, v22, v22
    v_rcp_f32 v49, v49
    v_fma_f32 v55, v55, v22, v22
    v_rcp_f32 v50, v50
    v_mul_f32 v48, v96, v48
    s_waitcnt lgkmcnt(4)
    v_mfma_f32_32x32x16_bf16 v[112:127], v[44:47], v[188:191], v[112:127]
    ds_read_b64_tr_b16 v[40:41], v15 offset:36864
    ds_read_b64_tr_b16 v[42:43], v15 offset:37376
    v_rcp_f32 v51, v51
    v_mul_f32 v49, v97, v49
    v_rcp_f32 v52, v52
    v_mul_f32 v50, v98, v50
    v_rcp_f32 v53, v53
    s_waitcnt lgkmcnt(4)
    v_mfma_f32_32x32x16_bf16 v[112:127], v[32:35], v[192:195], v[112:127]
    ds_read_b64_tr_b16 v[44:45], v15 offset:38912
    ds_read_b64_tr_b16 v[46:47], v15 offset:39424
    v_mul_f32 v51, v99, v51
    v_rcp_f32 v54, v54
    v_mul_f32 v52, v100, v52
    v_rcp_f32 v55, v55
    v_mul_f32 v53, v101, v53
    v_cvt_pk_bf16_f32 v96, v48, v49
    s_mov_b64 exec, 1
    ds_add_u32 v4, v5 offset:10244
    s_mov_b64 exec, -1
    s_waitcnt lgkmcnt(5)
    v_mfma_f32_32x32x16_bf16 v[112:127], v[36:39], v[196:199], v[112:127]
    ds_read_b64_tr_b16 v[32:33], v15 offset:40960
    ds_read_b64_tr_b16 v[34:35], v15 offset:41472
    v_mul_f32 v54, v102, v54
    v_cvt_pk_bf16_f32 v97, v50, v51
    v_mul_f32 v55, v103, v55
    v_cvt_pk_bf16_f32 v98, v52, v53
    v_cvt_pk_bf16_f32 v99, v54, v55
    s_add_u32 s94, s64, 57344
    buffer_store_dwordx4 v[96:99], v30, s[36:39], s94 offen offset:0 sc1
    s_waitcnt lgkmcnt(5)
    v_mfma_f32_32x32x16_bf16 v[112:127], v[40:43], v[200:203], v[112:127]
    ds_read_b64_tr_b16 v[36:37], v15 offset:43008
    ds_read_b64_tr_b16 v[38:39], v15 offset:43520
    v_mul_f32 v48, v104, v104
    v_mul_f32 v49, v105, v105
    v_mul_f32 v50, v106, v106
    v_mul_f32 v51, v107, v107
    v_mul_f32 v52, v108, v108
    s_waitcnt lgkmcnt(5)
    v_mfma_f32_32x32x16_bf16 v[112:127], v[44:47], v[204:207], v[112:127]
    ds_read_b64_tr_b16 v[40:41], v15 offset:45056
    ds_read_b64_tr_b16 v[42:43], v15 offset:45568
    v_mul_f32 v53, v109, v109
    v_mul_f32 v54, v110, v110
    v_mul_f32 v55, v111, v111
    v_fma_f32 v48, v48, v20, v2
    v_fma_f32 v49, v49, v20, v2
    v_fma_f32 v50, v50, v20, v2
    s_waitcnt lgkmcnt(4)
    v_mfma_f32_32x32x16_bf16 v[112:127], v[32:35], v[208:211], v[112:127]
    ds_read_b64_tr_b16 v[44:45], v15 offset:47104
    ds_read_b64_tr_b16 v[46:47], v15 offset:47616
    v_fma_f32 v51, v51, v20, v2
    v_fma_f32 v52, v52, v20, v2
    v_fma_f32 v53, v53, v20, v2
    v_fma_f32 v54, v54, v20, v2
    v_fma_f32 v55, v55, v20, v2
    s_waitcnt lgkmcnt(4)
    v_mfma_f32_32x32x16_bf16 v[112:127], v[36:39], v[212:215], v[112:127]
    ds_read_b64_tr_b16 v[32:33], v15 offset:49152
    ds_read_b64_tr_b16 v[34:35], v15 offset:49664
    v_mul_f32 v48, v104, v48
    v_mul_f32 v49, v105, v49
    v_mul_f32 v50, v106, v50
    v_mul_f32 v51, v107, v51
    v_mul_f32 v52, v108, v52
    v_mul_f32 v53, v109, v53
    s_waitcnt lgkmcnt(4)
    v_mfma_f32_32x32x16_bf16 v[112:127], v[40:43], v[216:219], v[112:127]
    ds_read_b64_tr_b16 v[36:37], v15 offset:51200
    ds_read_b64_tr_b16 v[38:39], v15 offset:51712
    v_mul_f32 v54, v110, v54
    v_mul_f32 v55, v111, v55
    v_exp_f32 v48, v48
    v_exp_f32 v49, v49
    v_exp_f32 v50, v50
    s_waitcnt lgkmcnt(4)
    v_mfma_f32_32x32x16_bf16 v[112:127], v[44:47], v[220:223], v[112:127]
    ds_read_b64_tr_b16 v[40:41], v15 offset:53248
    ds_read_b64_tr_b16 v[42:43], v15 offset:53760
    v_fma_f32 v48, v48, v22, v22
    v_exp_f32 v51, v51
    v_fma_f32 v49, v49, v22, v22
    v_exp_f32 v52, v52
    v_fma_f32 v50, v50, v22, v22
    v_exp_f32 v53, v53
    s_waitcnt lgkmcnt(4)
    v_mfma_f32_32x32x16_bf16 v[112:127], v[32:35], v[224:227], v[112:127]
    ds_read_b64_tr_b16 v[44:45], v15 offset:55296
    ds_read_b64_tr_b16 v[46:47], v15 offset:55808
    v_fma_f32 v51, v51, v22, v22
    v_exp_f32 v54, v54
    v_fma_f32 v52, v52, v22, v22
    v_exp_f32 v55, v55
    v_fma_f32 v53, v53, v22, v22
    s_waitcnt lgkmcnt(4)
    v_mfma_f32_32x32x16_bf16 v[112:127], v[36:39], v[228:231], v[112:127]
    ds_read_b64_tr_b16 v[32:33], v15 offset:57344
    ds_read_b64_tr_b16 v[34:35], v15 offset:57856
    v_rcp_f32 v48, v48
    v_fma_f32 v54, v54, v22, v22
    v_rcp_f32 v49, v49
    v_fma_f32 v55, v55, v22, v22
    v_rcp_f32 v50, v50
    v_mul_f32 v48, v104, v48
    s_waitcnt lgkmcnt(4)
    v_mfma_f32_32x32x16_bf16 v[112:127], v[40:43], v[232:235], v[112:127]
    ds_read_b64_tr_b16 v[36:37], v15 offset:59392
    ds_read_b64_tr_b16 v[38:39], v15 offset:59904
    v_rcp_f32 v51, v51
    v_mul_f32 v49, v105, v49
    v_rcp_f32 v52, v52
    v_mul_f32 v50, v106, v50
    v_rcp_f32 v53, v53
    s_waitcnt lgkmcnt(4)
    v_mfma_f32_32x32x16_bf16 v[112:127], v[44:47], v[236:239], v[112:127]
    ds_read_b64_tr_b16 v[40:41], v15 offset:61440
    ds_read_b64_tr_b16 v[42:43], v15 offset:61952
    v_mul_f32 v51, v107, v51
    v_rcp_f32 v54, v54
    v_mul_f32 v52, v108, v52
    v_rcp_f32 v55, v55
    v_mul_f32 v53, v109, v53
    v_cvt_pk_bf16_f32 v104, v48, v49
    s_waitcnt lgkmcnt(4)
    v_mfma_f32_32x32x16_bf16 v[112:127], v[32:35], v[240:243], v[112:127]
    ds_read_b64_tr_b16 v[44:45], v15 offset:63488
    ds_read_b64_tr_b16 v[46:47], v15 offset:64000
    v_mul_f32 v54, v110, v54
    v_cvt_pk_bf16_f32 v105, v50, v51
    v_mul_f32 v55, v111, v55
    v_cvt_pk_bf16_f32 v106, v52, v53
    v_cvt_pk_bf16_f32 v107, v54, v55
    buffer_store_dwordx4 v[104:107], v30, s[36:39], s94 offen offset:1024 sc1
    s_waitcnt lgkmcnt(4)
    v_mfma_f32_32x32x16_bf16 v[112:127], v[36:39], v[244:247], v[112:127]
    s_waitcnt lgkmcnt(0)
    s_mov_b64 exec, 1
    ds_add_u32 v4, v5 offset:10240
    s_mov_b64 exec, -1
    v_mfma_f32_32x32x16_bf16 v[112:127], v[40:43], v[248:251], v[112:127]
    s_waitcnt vmcnt(2)
    v_mov_b32 v6, 256
    s_mov_b32 exec_lo, s84
    s_mov_b32 exec_hi, 0
    buffer_atomic_add v6, v7, s[36:39], s68 offen sc1
    s_mov_b64 exec, -1
    v_mfma_f32_32x32x16_bf16 v[112:127], v[44:47], v[252:255], v[112:127]
    s_nop 11
    v_pk_mul_f32 v[48:49], v[112:113], v[112:113]
    v_pk_mul_f32 v[50:51], v[114:115], v[114:115]
    v_pk_mul_f32 v[52:53], v[116:117], v[116:117]
    v_pk_mul_f32 v[54:55], v[118:119], v[118:119]
    v_pk_fma_f32 v[48:49], v[48:49], v[20:21], v[2:3]
    v_pk_fma_f32 v[50:51], v[50:51], v[20:21], v[2:3]
    v_pk_fma_f32 v[52:53], v[52:53], v[20:21], v[2:3]
    v_pk_fma_f32 v[54:55], v[54:55], v[20:21], v[2:3]
    v_pk_mul_f32 v[48:49], v[112:113], v[48:49]
    v_pk_mul_f32 v[50:51], v[114:115], v[50:51]
    v_pk_mul_f32 v[52:53], v[116:117], v[52:53]
    v_pk_mul_f32 v[54:55], v[118:119], v[54:55]
    v_exp_f32 v48, v48
    v_exp_f32 v49, v49
    v_exp_f32 v50, v50
    v_exp_f32 v51, v51
    v_exp_f32 v52, v52
    v_exp_f32 v53, v53
    v_exp_f32 v54, v54
    v_exp_f32 v55, v55
    v_pk_fma_f32 v[48:49], v[48:49], v[22:23], v[22:23]
    v_pk_fma_f32 v[50:51], v[50:51], v[22:23], v[22:23]
    v_pk_fma_f32 v[52:53], v[52:53], v[22:23], v[22:23]
    v_pk_fma_f32 v[54:55], v[54:55], v[22:23], v[22:23]
    v_rcp_f32 v48, v48
    v_rcp_f32 v49, v49
    v_rcp_f32 v50, v50
    v_rcp_f32 v51, v51
    v_rcp_f32 v52, v52
    v_rcp_f32 v53, v53
    v_rcp_f32 v54, v54
    v_rcp_f32 v55, v55
    v_pk_mul_f32 v[48:49], v[112:113], v[48:49]
    v_pk_mul_f32 v[50:51], v[114:115], v[50:51]
    v_pk_mul_f32 v[52:53], v[116:117], v[52:53]
    v_pk_mul_f32 v[54:55], v[118:119], v[54:55]
    v_cvt_pk_bf16_f32 v112, v48, v49
    v_cvt_pk_bf16_f32 v113, v50, v51
    v_cvt_pk_bf16_f32 v114, v52, v53
    v_cvt_pk_bf16_f32 v115, v54, v55
    s_add_u32 s94, s64, 86016
    buffer_store_dwordx4 v[112:115], v30, s[36:39], s94 offen offset:0 sc1
    v_pk_mul_f32 v[48:49], v[120:121], v[120:121]
    v_pk_mul_f32 v[50:51], v[122:123], v[122:123]
    v_pk_mul_f32 v[52:53], v[124:125], v[124:125]
    v_pk_mul_f32 v[54:55], v[126:127], v[126:127]
    v_pk_fma_f32 v[48:49], v[48:49], v[20:21], v[2:3]
    v_pk_fma_f32 v[50:51], v[50:51], v[20:21], v[2:3]
    v_pk_fma_f32 v[52:53], v[52:53], v[20:21], v[2:3]
    v_pk_fma_f32 v[54:55], v[54:55], v[20:21], v[2:3]
    v_pk_mul_f32 v[48:49], v[120:121], v[48:49]
    v_pk_mul_f32 v[50:51], v[122:123], v[50:51]
    v_pk_mul_f32 v[52:53], v[124:125], v[52:53]
    v_pk_mul_f32 v[54:55], v[126:127], v[54:55]
    v_exp_f32 v48, v48
    v_exp_f32 v49, v49
    v_exp_f32 v50, v50
    v_exp_f32 v51, v51
    v_exp_f32 v52, v52
    v_exp_f32 v53, v53
    v_exp_f32 v54, v54
    v_exp_f32 v55, v55
    v_pk_fma_f32 v[48:49], v[48:49], v[22:23], v[22:23]
    v_pk_fma_f32 v[50:51], v[50:51], v[22:23], v[22:23]
    v_pk_fma_f32 v[52:53], v[52:53], v[22:23], v[22:23]
    v_pk_fma_f32 v[54:55], v[54:55], v[22:23], v[22:23]
    v_rcp_f32 v48, v48
    v_rcp_f32 v49, v49
    v_rcp_f32 v50, v50
    v_rcp_f32 v51, v51
    v_rcp_f32 v52, v52
    v_rcp_f32 v53, v53
    v_rcp_f32 v54, v54
    v_rcp_f32 v55, v55
    v_pk_mul_f32 v[48:49], v[120:121], v[48:49]
    v_pk_mul_f32 v[50:51], v[122:123], v[50:51]
    v_pk_mul_f32 v[52:53], v[124:125], v[52:53]
    v_pk_mul_f32 v[54:55], v[126:127], v[54:55]
    v_cvt_pk_bf16_f32 v120, v48, v49
    v_cvt_pk_bf16_f32 v121, v50, v51
    v_cvt_pk_bf16_f32 v122, v52, v53
    v_cvt_pk_bf16_f32 v123, v54, v55
    buffer_store_dwordx4 v[120:123], v30, s[36:39], s94 offen offset:1024 sc1
    s_waitcnt vmcnt(3)
    v_mov_b32 v6, 65536
    s_mov_b32 exec_lo, s84
    s_mov_b32 exec_hi, 0
    buffer_atomic_add v6, v7, s[36:39], s68 offen sc1
    s_mov_b64 exec, -1
    s_waitcnt vmcnt(1)
    v_mov_b32 v6, 16777216
    s_mov_b32 exec_lo, s84
    s_mov_b32 exec_hi, 0
    buffer_atomic_add v6, v7, s[36:39], s68 offen sc1
    s_mov_b64 exec, -1
    s_endpgm
L_helper:
    s_lshr_b32 s59, s23, 1
    s_mul_i32 s56, s60, 7
    s_add_u32 s56, s56, s59
    s_and_b32 s65, s23, 1
    s_lshl1_add_u32 s64, s56, s65
    v_lshrrev_b32 v3, 3, v1
    v_and_b32 v4, 7, v1
    s_and_b32 s62, s20, 3
    s_lshl_b32 s59, s65, 5
    s_add_u32 s59, s59, s62
    s_mul_i32 s59, s59, 28672
    s_lshr_b32 s61, s20, 2
    s_lshl_b32 s68, s61, 8
    s_lshl1_add_u32 s61, s56, s61
    s_lshl_b32 s61, s61, 7
    s_lshl_b32 s62, s62, 12
    s_add_u32 s68, s68, s62
    v_mul_u32_u24 v2, 3584, v3
    v_lshl_add_u32 v2, v4, 4, v2
    s_add_u32 s61, s61, s59
    s_mov_b32 s30, 1835008
    s_mov_b32 s31, 0x00020000
    s_waitcnt lgkmcnt(0)
    s_mov_b64 s[28:29], s[6:7]
    s_mov_b64 s[36:37], s[18:19]
    s_mov_b32 s38, 268435456
    s_mov_b32 s39, 0x00020000
    s_mov_b64 s[44:45], s[16:17]
    s_mov_b32 s46, 256
    s_mov_b32 s47, 0x00020000
    s_cmp_ge_u32 s23, 14
    s_cbranch_scc1 L_nojob
    s_add_u32 s94, s61, 0
    buffer_load_dwordx4 v[64:67], v2, s[28:31], s94 offen
    s_add_u32 s94, s61, 114688
    buffer_load_dwordx4 v[68:71], v2, s[28:31], s94 offen
    s_add_u32 s94, s61, 229376
    buffer_load_dwordx4 v[72:75], v2, s[28:31], s94 offen
    s_add_u32 s94, s61, 344064
    buffer_load_dwordx4 v[76:79], v2, s[28:31], s94 offen
    s_add_u32 s94, s61, 458752
    buffer_load_dwordx4 v[80:83], v2, s[28:31], s94 offen
    s_add_u32 s94, s61, 573440
    buffer_load_dwordx4 v[84:87], v2, s[28:31], s94 offen
    s_add_u32 s94, s61, 688128
    buffer_load_dwordx4 v[88:91], v2, s[28:31], s94 offen
    s_add_u32 s94, s61, 802816
    buffer_load_dwordx4 v[92:95], v2, s[28:31], s94 offen
    s_mov_b64 s[48:49], s[8:9]
    s_mov_b32 s50, 3584
    s_mov_b32 s51, 0x00020000
    v_lshlrev_b32 v6, 2, v1
    s_lshl_b32 s59, s56, 8
    buffer_load_dword v7, v6, s[48:51], s59 offen
    v_mov_b32 v96, 0
    v_mov_b32 v97, 0
    v_mov_b32 v98, 0
    v_mov_b32 v99, 0
    v_mov_b32 v100, 0
    v_mov_b32 v101, 0
    v_mov_b32 v102, 0
    v_mov_b32 v103, 0
    v_lshlrev_b32 v8, 9, v3
    v_lshl_add_u32 v8, v4, 5, v8
    v_add_u32 v8, s68, v8
    v_lshlrev_b32 v9, 3, v1
    v_add_u32 v9, 0, v9
    s_waitcnt vmcnt(8)
    v_lshlrev_b32 v104, 16, v64
    v_and_b32 v105, 0xffff0000, v64
    v_lshlrev_b32 v106, 16, v65
    v_and_b32 v107, 0xffff0000, v65
    v_lshlrev_b32 v108, 16, v66
    v_and_b32 v109, 0xffff0000, v66
    v_lshlrev_b32 v110, 16, v67
    v_and_b32 v111, 0xffff0000, v67
    v_pk_add_f32 v[96:97], v[96:97], v[104:105]
    v_pk_add_f32 v[98:99], v[98:99], v[106:107]
    v_pk_add_f32 v[100:101], v[100:101], v[108:109]
    v_pk_add_f32 v[102:103], v[102:103], v[110:111]
    s_waitcnt vmcnt(7)
    v_lshlrev_b32 v104, 16, v68
    v_and_b32 v105, 0xffff0000, v68
    v_lshlrev_b32 v106, 16, v69
    v_and_b32 v107, 0xffff0000, v69
    v_lshlrev_b32 v108, 16, v70
    v_and_b32 v109, 0xffff0000, v70
    v_lshlrev_b32 v110, 16, v71
    v_and_b32 v111, 0xffff0000, v71
    v_pk_add_f32 v[96:97], v[96:97], v[104:105]
    v_pk_add_f32 v[98:99], v[98:99], v[106:107]
    v_pk_add_f32 v[100:101], v[100:101], v[108:109]
    v_pk_add_f32 v[102:103], v[102:103], v[110:111]
    s_waitcnt vmcnt(6)
    v_lshlrev_b32 v104, 16, v72
    v_and_b32 v105, 0xffff0000, v72
    v_lshlrev_b32 v106, 16, v73
    v_and_b32 v107, 0xffff0000, v73
    v_lshlrev_b32 v108, 16, v74
    v_and_b32 v109, 0xffff0000, v74
    v_lshlrev_b32 v110, 16, v75
    v_and_b32 v111, 0xffff0000, v75
    v_pk_add_f32 v[96:97], v[96:97], v[104:105]
    v_pk_add_f32 v[98:99], v[98:99], v[106:107]
    v_pk_add_f32 v[100:101], v[100:101], v[108:109]
    v_pk_add_f32 v[102:103], v[102:103], v[110:111]
    s_waitcnt vmcnt(5)
    v_lshlrev_b32 v104, 16, v76
    v_and_b32 v105, 0xffff0000, v76
    v_lshlrev_b32 v106, 16, v77
    v_and_b32 v107, 0xffff0000, v77
    v_lshlrev_b32 v108, 16, v78
    v_and_b32 v109, 0xffff0000, v78
    v_lshlrev_b32 v110, 16, v79
    v_and_b32 v111, 0xffff0000, v79
    v_pk_add_f32 v[96:97], v[96:97], v[104:105]
    v_pk_add_f32 v[98:99], v[98:99], v[106:107]
    v_pk_add_f32 v[100:101], v[100:101], v[108:109]
    v_pk_add_f32 v[102:103], v[102:103], v[110:111]
    s_waitcnt vmcnt(4)
    v_lshlrev_b32 v104, 16, v80
    v_and_b32 v105, 0xffff0000, v80
    v_lshlrev_b32 v106, 16, v81
    v_and_b32 v107, 0xffff0000, v81
    v_lshlrev_b32 v108, 16, v82
    v_and_b32 v109, 0xffff0000, v82
    v_lshlrev_b32 v110, 16, v83
    v_and_b32 v111, 0xffff0000, v83
    v_pk_add_f32 v[96:97], v[96:97], v[104:105]
    v_pk_add_f32 v[98:99], v[98:99], v[106:107]
    v_pk_add_f32 v[100:101], v[100:101], v[108:109]
    v_pk_add_f32 v[102:103], v[102:103], v[110:111]
    s_waitcnt vmcnt(3)
    v_lshlrev_b32 v104, 16, v84
    v_and_b32 v105, 0xffff0000, v84
    v_lshlrev_b32 v106, 16, v85
    v_and_b32 v107, 0xffff0000, v85
    v_lshlrev_b32 v108, 16, v86
    v_and_b32 v109, 0xffff0000, v86
    v_lshlrev_b32 v110, 16, v87
    v_and_b32 v111, 0xffff0000, v87
    v_pk_add_f32 v[96:97], v[96:97], v[104:105]
    v_pk_add_f32 v[98:99], v[98:99], v[106:107]
    v_pk_add_f32 v[100:101], v[100:101], v[108:109]
    v_pk_add_f32 v[102:103], v[102:103], v[110:111]
    s_waitcnt vmcnt(2)
    v_lshlrev_b32 v104, 16, v88
    v_and_b32 v105, 0xffff0000, v88
    v_lshlrev_b32 v106, 16, v89
    v_and_b32 v107, 0xffff0000, v89
    v_lshlrev_b32 v108, 16, v90
    v_and_b32 v109, 0xffff0000, v90
    v_lshlrev_b32 v110, 16, v91
    v_and_b32 v111, 0xffff0000, v91
    v_pk_add_f32 v[96:97], v[96:97], v[104:105]
    v_pk_add_f32 v[98:99], v[98:99], v[106:107]
    v_pk_add_f32 v[100:101], v[100:101], v[108:109]
    v_pk_add_f32 v[102:103], v[102:103], v[110:111]
    s_waitcnt vmcnt(1)
    v_lshlrev_b32 v104, 16, v92
    v_and_b32 v105, 0xffff0000, v92
    v_lshlrev_b32 v106, 16, v93
    v_and_b32 v107, 0xffff0000, v93
    v_lshlrev_b32 v108, 16, v94
    v_and_b32 v109, 0xffff0000, v94
    v_lshlrev_b32 v110, 16, v95
    v_and_b32 v111, 0xffff0000, v95
    v_pk_add_f32 v[96:97], v[96:97], v[104:105]
    v_pk_add_f32 v[98:99], v[98:99], v[106:107]
    v_pk_add_f32 v[100:101], v[100:101], v[108:109]
    v_pk_add_f32 v[102:103], v[102:103], v[110:111]
    s_cmp_lg_u32 s20, 4
    s_cbranch_scc1 L_nomk18
    buffer_load_dwordx4 v[12:15], off, s[44:47], 0 sc1
L_nomk18:
    ds_write_b128 v8, v[96:99]
    ds_write_b128 v8, v[100:103] offset:16
    s_waitcnt lgkmcnt(0)
    s_barrier
    s_cmp_lg_u32 s20, 4
    s_cbranch_scc1 L_jobwait
    s_setprio 3
    ds_read_b64 v[128:129], v9 offset:0
    ds_read_b64 v[130:131], v9 offset:512
    ds_read_b64 v[132:133], v9 offset:1024
    ds_read_b64 v[134:135], v9 offset:1536
    ds_read_b64 v[136:137], v9 offset:2048
    ds_read_b64 v[138:139], v9 offset:2560
    ds_read_b64 v[140:141], v9 offset:3072
    ds_read_b64 v[142:143], v9 offset:3584
    ds_read_b64 v[144:145], v9 offset:4096
    ds_read_b64 v[146:147], v9 offset:4608
    ds_read_b64 v[148:149], v9 offset:5120
    ds_read_b64 v[150:151], v9 offset:5632
    ds_read_b64 v[152:153], v9 offset:6144
    ds_read_b64 v[154:155], v9 offset:6656
    ds_read_b64 v[156:157], v9 offset:7168
    ds_read_b64 v[158:159], v9 offset:7680
    ds_read_b64 v[160:161], v9 offset:8192
    ds_read_b64 v[162:163], v9 offset:8704
    ds_read_b64 v[164:165], v9 offset:9216
    ds_read_b64 v[166:167], v9 offset:9728
    ds_read_b64 v[168:169], v9 offset:10240
    ds_read_b64 v[170:171], v9 offset:10752
    ds_read_b64 v[172:173], v9 offset:11264
    ds_read_b64 v[174:175], v9 offset:11776
    ds_read_b64 v[176:177], v9 offset:12288
    ds_read_b64 v[178:179], v9 offset:12800
    ds_read_b64 v[180:181], v9 offset:13312
    ds_read_b64 v[182:183], v9 offset:13824
    ds_read_b64 v[184:185], v9 offset:14336
    ds_read_b64 v[186:187], v9 offset:14848
    ds_read_b64 v[188:189], v9 offset:15360
    ds_read_b64 v[190:191], v9 offset:15872
    s_waitcnt lgkmcnt(0)
    v_pk_add_f32 v[128:129], v[128:129], v[160:161]
    v_pk_add_f32 v[130:131], v[130:131], v[162:163]
    v_pk_add_f32 v[132:133], v[132:133], v[164:165]
    v_pk_add_f32 v[134:135], v[134:135], v[166:167]
    v_pk_add_f32 v[136:137], v[136:137], v[168:169]
    v_pk_add_f32 v[138:139], v[138:139], v[170:171]
    v_pk_add_f32 v[140:141], v[140:141], v[172:173]
    v_pk_add_f32 v[142:143], v[142:143], v[174:175]
    v_pk_add_f32 v[144:145], v[144:145], v[176:177]
    v_pk_add_f32 v[146:147], v[146:147], v[178:179]
    v_pk_add_f32 v[148:149], v[148:149], v[180:181]
    v_pk_add_f32 v[150:151], v[150:151], v[182:183]
    v_pk_add_f32 v[152:153], v[152:153], v[184:185]
    v_pk_add_f32 v[154:155], v[154:155], v[186:187]
    v_pk_add_f32 v[156:157], v[156:157], v[188:189]
    v_pk_add_f32 v[158:159], v[158:159], v[190:191]
    v_pk_add_f32 v[128:129], v[128:129], v[144:145]
    v_pk_add_f32 v[130:131], v[130:131], v[146:147]
    v_pk_add_f32 v[132:133], v[132:133], v[148:149]
    v_pk_add_f32 v[134:135], v[134:135], v[150:151]
    v_pk_add_f32 v[136:137], v[136:137], v[152:153]
    v_pk_add_f32 v[138:139], v[138:139], v[154:155]
    v_pk_add_f32 v[140:141], v[140:141], v[156:157]
    v_pk_add_f32 v[142:143], v[142:143], v[158:159]
    v_pk_add_f32 v[128:129], v[128:129], v[136:137]
    v_pk_add_f32 v[130:131], v[130:131], v[138:139]
    v_pk_add_f32 v[132:133], v[132:133], v[140:141]
    v_pk_add_f32 v[134:135], v[134:135], v[142:143]
    v_pk_add_f32 v[128:129], v[128:129], v[132:133]
    v_pk_add_f32 v[130:131], v[130:131], v[134:135]
    v_pk_add_f32 v[128:129], v[128:129], v[130:131]
    s_waitcnt vmcnt(0)
    s_cmp_eq_u32 s65, 0
    s_cselect_b32 s59, -1, 0
    v_and_b32 v11, s59, v7
    v_lshlrev_b32 v10, 16, v11
    s_mov_b32 s59, 0x07060302
    v_and_b32 v108, 0xffff0000, v128
    v_sub_f32 v109, v128, v108
    v_and_b32 v108, 0xffff0000, v109
    v_sub_f32 v108, v109, v108
    v_perm_b32 v104, v109, v128, s59
    v_perm_b32 v105, v10, v108, s59
    v_or_b32 v105, 1, v105
    v_and_b32 v110, 0xffff0000, v129
    v_sub_f32 v111, v129, v110
    v_and_b32 v110, 0xffff0000, v111
    v_sub_f32 v110, v111, v110
    v_perm_b32 v106, v111, v129, s59
    v_perm_b32 v107, v11, v110, s59
    v_or_b32 v107, 1, v107
    v_lshlrev_b32 v6, 4, v1
    s_waitcnt vmcnt(0)
    s_mov_b32 s63, 0
L_nz19:
    v_and_b32 v12, v12, v13
    v_bitop3_b32 v12, v12, v14, v15 bitop3:0x80
    s_add_u32 s63, s63, 1
    v_readfirstlane_b32 s59, v12
    s_nop 0
    s_cmp_lg_u32 s59, 0
    s_cbranch_scc1 L_nd20
    s_sleep 4
    buffer_load_dwordx4 v[12:15], off, s[44:47], 0 sc1
    s_waitcnt vmcnt(0)
    s_cmp_lt_u32 s63, 0x100000
    s_cbranch_scc1 L_nz19
    s_endpgm
L_nd20:
    s_lshl_b32 s59, s64, 10
    s_add_u32 s59, s59, 8404992
    buffer_store_dwordx4 v[104:107], v6, s[36:39], s59 offen sc1
L_jobwait:
    s_barrier
    s_branch L_jobend
L_nojob:
    s_and_b32 s59, s23, 1
    s_lshl1_add_u32 s59, s59, s60
    v_mov_b32 v8, 0
    v_mov_b32 v9, 0
    v_mov_b32 v10, 0
    v_mov_b32 v11, 0
    v_lshlrev_b32 v2, 4, v0
    s_lshl_b32 s94, s59, 13
    s_add_u32 s94, s94, 8404992
    buffer_store_dwordx4 v[8:11], v2, s[36:39], s94 offen sc1
    s_lshl3_add_u32 s61, s59, s20
    s_mul_i32 s61, s61, 512
    s_add_u32 s61, s61, 8388608
    v_lshlrev_b32 v3, 4, v1
    s_mov_b64 exec, 0xffffffff
    buffer_store_dwordx4 v[8:11], v3, s[36:39], s61 offen sc1
    s_mov_b64 exec, -1
    s_mov_b32 s62, s59
    s_mov_b32 s59, s62
    s_waitcnt vmcnt(0)
    s_barrier
    s_cmp_lg_u32 s20, 0
    s_cbranch_scc1 L_jobend
    v_mov_b32 v4, 1
    s_lshl_b32 s59, s59, 2
    s_mov_b64 exec, 1
    buffer_store_dword v4, off, s[44:47], s59 sc1
    s_mov_b64 exec, -1
L_jobend:
    s_cmp_lt_u32 s20, 4
    s_cbranch_scc1 L_hp2
    s_setprio 3
    s_endpgm
L_hp2:
    s_and_b32 s59, s22, 3
    s_lshl2_add_u32 s57, s21, s59
    s_mov_b32 s58, 3
    s_mov_b64 s[32:33], s[10:11]
    s_mov_b32 s34, 1835008
    s_mov_b32 s35, 0x00020000
    s_mov_b64 s[40:41], s[14:15]
    s_mov_b32 s42, 2097152
    s_mov_b32 s43, 0x00020000
    s_mov_b64 s[52:53], s[12:13]
    s_mov_b32 s54, 1024
    s_mov_b32 s55, 0x00020000
    v_lshrrev_b32 v29, 3, v1
    v_and_b32 v30, 7, v1
    v_lshrrev_b32 v32, 2, v1
    v_and_b32 v32, 4, v32
    v_xor_b32 v32, v30, v32
    v_lshlrev_b32 v32, 4, v32
    v_lshl_add_u32 v10, v29, 10, v32
    v_add_u32 v11, 7168, v10
    s_lshr_b32 s59, s20, 1
    s_mul_i32 s100, s59, 917504
    s_lshl_b32 s59, s58, 7
    s_add_u32 s100, s100, s59
    s_and_b32 s60, s20, 1
    s_mul_i32 s61, s60, 507904
    s_add_u32 s101, s100, s61
    s_mul_i32 s61, s60, 409600
    s_add_u32 s100, s100, s61
    s_mul_i32 s3, s20, 6144
    s_lshl_b32 s99, s20, 13
    s_add_u32 s99, s99, 98304
    s_lshl2_add_u32 s88, s57, s20
    s_mul_i32 s88, s88, 128
    s_add_u32 s88, s88, 8388608
    s_add_u32 s88, s88, s18
    s_addc_u32 s89, s19, 0
    v_lshlrev_b32 v12, 4, v1
    v_mov_b32 v24, 0
    v_bfe_u32 v29, v1, 2, 2
    v_and_b32 v30, 3, v1
    v_lshlrev_b32 v30, 3, v30
    v_lshl_add_u32 v30, v29, 7, v30
    v_bfe_u32 v32, v1, 3, 1
    v_lshl_add_u32 v30, v32, 6, v30
    v_lshrrev_b32 v32, 5, v1
    v_lshl_add_u32 v33, v32, 9, v30
    v_bfe_u32 v34, v1, 4, 1
    v_lshl_add_u32 v33, v34, 5, v33
    s_lshr_b32 s59, s20, 1
    s_lshl_b32 s59, s59, 6
    v_xor_b32 v33, s59, v33
    v_xor_b32 v34, 64, v33
    v_add_u32 v13, s3, v33
    v_add_u32 v14, s3, v34
    v_add_u32 v15, 73728, v13
    v_add_u32 v16, 73728, v14
    v_add_u32 v17, s99, v33
    v_add_u32 v18, s99, v34
    s_lshl1_add_u32 s59, s57, s60
    s_mul_i32 s95, s59, 114688
    s_xor_b32 s61, s59, 1
    s_mul_i32 s96, s61, 114688
    s_mul_i32 s61, s20, 7168
    s_add_u32 s95, s95, s61
    s_add_u32 s96, s96, s61
    v_and_b32 v33, 31, v1
    v_lshlrev_b32 v36, 10, v33
    v_lshl_add_u32 v36, v32, 4, v36
    s_lshl_b32 s59, s59, 15
    s_lshr_b32 s61, s20, 1
    s_lshl1_add_u32 s61, s58, s61
    s_lshl_b32 s61, s61, 6
    s_add_u32 s59, s59, s61
    v_add_u32 v36, s59, v36
    v_lshlrev_b32 v32, 3, v32
    buffer_load_dwordx2 v[40:41], v32, s[52:55], s61 offen offset:0
    buffer_load_dwordx2 v[42:43], v32, s[52:55], s61 offen offset:16
    buffer_load_dwordx2 v[44:45], v32, s[52:55], s61 offen offset:32
    buffer_load_dwordx2 v[46:47], v32, s[52:55], s61 offen offset:48
    v_mul_u32_u24 v38, 144, v33
    v_add_u32 v38, v38, v32
    s_mul_i32 s59, s60, 4608
    s_lshr_b32 s61, s20, 1
    s_lshl_b32 s61, s61, 6
    s_add_u32 s59, s59, s61
    v_add_u32 v38, s59, v38
    v_lshrrev_b32 v29, 3, v1
    v_and_b32 v30, 7, v1
    v_lshlrev_b32 v30, 4, v30
    v_mul_u32_u24 v39, 144, v29
    v_add_u32 v39, v39, v30
    s_mul_i32 s59, s20, 2304
    v_add_u32 v39, s59, v39
    v_lshl_add_u32 v36, v29, 10, v30
    s_lshl2_add_u32 s59, s57, s20
    s_lshl_b32 s59, s59, 14
    s_lshl_b32 s61, s58, 7
    s_add_u32 s59, s59, s61
    v_add_u32 v36, s59, v36
    v_add_u32 v37, s99, v12
    s_xor_b32 s59, s20, 1
    s_lshl_b32 s59, s59, 13
    s_add_u32 s59, s59, 98304
    v_add_u32 v25, s59, v12
    s_xor_b32 s59, s20, 2
    s_lshl_b32 s59, s59, 13
    s_add_u32 s59, s59, 102400
    v_add_u32 v26, s59, v12
    s_xor_b32 s59, s20, 3
    s_lshl_b32 s59, s59, 13
    s_add_u32 s59, s59, 131072
    v_add_u32 v27, s59, v12
    buffer_load_dwordx4 v[20:23], off, s[44:47], 0 sc1
    s_add_u32 m0, s99, 38912
    s_add_u32 s94, s100, 0
    buffer_load_dwordx4 v10, s[32:35], s94 offen offset:0  lds
    buffer_load_dwordx4 v11, s[32:35], s94 offen offset:1024  lds
    s_add_u32 m0, s99, 36864
    s_add_u32 s94, s101, 16384
    buffer_load_dwordx4 v10, s[32:35], s94 offen offset:0  lds
    buffer_load_dwordx4 v11, s[32:35], s94 offen offset:1024  lds
    s_add_u32 m0, s99, 34816
    s_add_u32 s94, s100, 131072
    buffer_load_dwordx4 v10, s[32:35], s94 offen offset:0  lds
    buffer_load_dwordx4 v11, s[32:35], s94 offen offset:1024  lds
    s_add_u32 m0, s99, 32768
    s_add_u32 s94, s101, 147456
    buffer_load_dwordx4 v10, s[32:35], s94 offen offset:0  lds
    buffer_load_dwordx4 v11, s[32:35], s94 offen offset:1024  lds
    s_waitcnt vmcnt(9)
    v_lshlrev_b32 v64, 16, v40
    v_and_b32 v65, 0xffff0000, v40
    v_lshlrev_b32 v66, 16, v41
    v_and_b32 v67, 0xffff0000, v41
    v_lshlrev_b32 v68, 16, v42
    v_and_b32 v69, 0xffff0000, v42
    v_lshlrev_b32 v70, 16, v43
    v_and_b32 v71, 0xffff0000, v43
    v_lshlrev_b32 v72, 16, v44
    v_and_b32 v73, 0xffff0000, v44
    v_lshlrev_b32 v74, 16, v45
    v_and_b32 v75, 0xffff0000, v45
    v_lshlrev_b32 v76, 16, v46
    v_and_b32 v77, 0xffff0000, v46
    v_lshlrev_b32 v78, 16, v47
    v_and_b32 v79, 0xffff0000, v47
    s_waitcnt vmcnt(8)
    s_mov_b32 s63, 0
L_nz21:
    v_and_b32 v20, v20, v21
    v_bitop3_b32 v20, v20, v22, v23 bitop3:0x80
    s_add_u32 s63, s63, 1
    v_readfirstlane_b32 s59, v20
    s_nop 0
    s_cmp_lg_u32 s59, 0
    s_cbranch_scc1 L_nd22
    s_sleep 4
    buffer_load_dwordx4 v[20:23], off, s[44:47], 0 sc1
    s_waitcnt vmcnt(0)
    s_cmp_lt_u32 s63, 0x100000
    s_cbranch_scc1 L_nz21
    s_endpgm
L_nd22:
    s_add_u32 m0, s99, 6144
    s_add_u32 s94, s100, 262144
    buffer_load_dwordx4 v10, s[32:35], s94 offen offset:0  lds
    buffer_load_dwordx4 v11, s[32:35], s94 offen offset:1024  lds
    s_add_u32 m0, s99, 4096
    s_add_u32 s94, s101, 278528
    buffer_load_dwordx4 v10, s[32:35], s94 offen offset:0  lds
    buffer_load_dwordx4 v11, s[32:35], s94 offen offset:1024  lds
    s_add_u32 m0, s99, 2048
    s_add_u32 s94, s100, 393216
    buffer_load_dwordx4 v10, s[32:35], s94 offen offset:0  lds
    buffer_load_dwordx4 v11, s[32:35], s94 offen offset:1024  lds
    s_waitcnt vmcnt(12)
    ds_read_b64_tr_b16 v[128:129], v17 offset:38912
    ds_read_b64_tr_b16 v[130:131], v17 offset:39936
    ds_read_b64_tr_b16 v[132:133], v18 offset:38912
    ds_read_b64_tr_b16 v[134:135], v18 offset:39936
    s_waitcnt lgkmcnt(0)
    s_add_u32 m0, s99, 38912
    s_add_u32 s94, s100, 32768
    buffer_load_dwordx4 v10, s[32:35], s94 offen offset:0  lds
    buffer_load_dwordx4 v11, s[32:35], s94 offen offset:1024  lds
    s_waitcnt vmcnt(12)
    ds_read_b64_tr_b16 v[136:137], v17 offset:36864
    ds_read_b64_tr_b16 v[138:139], v17 offset:37888
    ds_read_b64_tr_b16 v[140:141], v18 offset:36864
    ds_read_b64_tr_b16 v[142:143], v18 offset:37888
    s_waitcnt lgkmcnt(0)
    s_add_u32 m0, s99, 36864
    s_add_u32 s94, s101, 49152
    buffer_load_dwordx4 v10, s[32:35], s94 offen offset:0  lds
    buffer_load_dwordx4 v11, s[32:35], s94 offen offset:1024  lds
    s_waitcnt vmcnt(12)
    ds_read_b64_tr_b16 v[144:145], v17 offset:34816
    ds_read_b64_tr_b16 v[146:147], v17 offset:35840
    ds_read_b64_tr_b16 v[148:149], v18 offset:34816
    ds_read_b64_tr_b16 v[150:151], v18 offset:35840
    s_add_u32 m0, s3, 0
    s_add_u32 s94, s100, 163840
    buffer_load_dwordx4 v10, s[32:35], s94 offen offset:0  lds
    buffer_load_dwordx4 v11, s[32:35], s94 offen offset:1024  lds
    s_waitcnt vmcnt(12)
    ds_read_b64_tr_b16 v[152:153], v17 offset:32768
    ds_read_b64_tr_b16 v[154:155], v17 offset:33792
    ds_read_b64_tr_b16 v[156:157], v18 offset:32768
    ds_read_b64_tr_b16 v[158:159], v18 offset:33792
    s_add_u32 m0, s3, 2048
    s_add_u32 s94, s101, 180224
    buffer_load_dwordx4 v10, s[32:35], s94 offen offset:0  lds
    buffer_load_dwordx4 v11, s[32:35], s94 offen offset:1024  lds
    s_waitcnt vmcnt(12)
    ds_read_b64_tr_b16 v[160:161], v17 offset:6144
    ds_read_b64_tr_b16 v[162:163], v17 offset:7168
    ds_read_b64_tr_b16 v[164:165], v18 offset:6144
    ds_read_b64_tr_b16 v[166:167], v18 offset:7168
    s_add_u32 m0, s3, 24576
    s_add_u32 s94, s100, 294912
    buffer_load_dwordx4 v10, s[32:35], s94 offen offset:0  lds
    buffer_load_dwordx4 v11, s[32:35], s94 offen offset:1024  lds
    s_waitcnt vmcnt(12)
    ds_read_b64_tr_b16 v[168:169], v17 offset:4096
    ds_read_b64_tr_b16 v[170:171], v17 offset:5120
    ds_read_b64_tr_b16 v[172:173], v18 offset:4096
    ds_read_b64_tr_b16 v[174:175], v18 offset:5120
    s_add_u32 m0, s3, 26624
    s_add_u32 s94, s101, 311296
    buffer_load_dwordx4 v10, s[32:35], s94 offen offset:0  lds
    buffer_load_dwordx4 v11, s[32:35], s94 offen offset:1024  lds
    s_waitcnt vmcnt(12)
    ds_read_b64_tr_b16 v[176:177], v17 offset:2048
    ds_read_b64_tr_b16 v[178:179], v17 offset:3072
    ds_read_b64_tr_b16 v[180:181], v18 offset:2048
    ds_read_b64_tr_b16 v[182:183], v18 offset:3072
    s_add_u32 m0, s3, 28672
    s_add_u32 s94, s100, 425984
    buffer_load_dwordx4 v10, s[32:35], s94 offen offset:0  lds
    buffer_load_dwordx4 v11, s[32:35], s94 offen offset:1024  lds
    s_waitcnt vmcnt(12)
    ds_read_b64_tr_b16 v[184:185], v17 offset:38912
    ds_read_b64_tr_b16 v[186:187], v17 offset:39936
    ds_read_b64_tr_b16 v[188:189], v18 offset:38912
    ds_read_b64_tr_b16 v[190:191], v18 offset:39936
    s_add_u32 m0, s3, 49152
    s_add_u32 s94, s100, 65536
    buffer_load_dwordx4 v10, s[32:35], s94 offen offset:0  lds
    buffer_load_dwordx4 v11, s[32:35], s94 offen offset:1024  lds
    s_waitcnt vmcnt(12)
    ds_read_b64_tr_b16 v[192:193], v17 offset:36864
    ds_read_b64_tr_b16 v[194:195], v17 offset:37888
    ds_read_b64_tr_b16 v[196:197], v18 offset:36864
    ds_read_b64_tr_b16 v[198:199], v18 offset:37888
    s_add_u32 m0, s3, 51200
    s_add_u32 s94, s101, 81920
    buffer_load_dwordx4 v10, s[32:35], s94 offen offset:0  lds
    buffer_load_dwordx4 v11, s[32:35], s94 offen offset:1024  lds
    s_add_u32 m0, s3, 53248
    s_add_u32 s94, s100, 196608
    buffer_load_dwordx4 v10, s[32:35], s94 offen offset:0  lds
    buffer_load_dwordx4 v11, s[32:35], s94 offen offset:1024  lds
    s_add_u32 m0, s3, 73728
    s_add_u32 s94, s101, 212992
    buffer_load_dwordx4 v10, s[32:35], s94 offen offset:0  lds
    buffer_load_dwordx4 v11, s[32:35], s94 offen offset:1024  lds
    s_add_u32 m0, s3, 75776
    s_add_u32 s94, s100, 327680
    buffer_load_dwordx4 v10, s[32:35], s94 offen offset:0  lds
    buffer_load_dwordx4 v11, s[32:35], s94 offen offset:1024  lds
    s_add_u32 m0, s3, 77824
    s_add_u32 s94, s101, 344064
    buffer_load_dwordx4 v10, s[32:35], s94 offen offset:0  lds
    buffer_load_dwordx4 v11, s[32:35], s94 offen offset:1024  lds
    s_add_u32 m0, s99, 0
    s_add_u32 s94, s100, 458752
    buffer_load_dwordx4 v10, s[32:35], s94 offen offset:0  lds
    buffer_load_dwordx4 v11, s[32:35], s94 offen offset:1024  lds
    s_waitcnt lgkmcnt(8)
    s_add_u32 m0, s99, 2048
    s_add_u32 s94, s100, 98304
    buffer_load_dwordx4 v10, s[32:35], s94 offen offset:0  lds
    buffer_load_dwordx4 v11, s[32:35], s94 offen offset:1024  lds
    s_load_dword s93, s[88:89], 0 glc
    s_add_u32 m0, s99, 4096
    s_add_u32 s94, s101, 114688
    buffer_load_dwordx4 v10, s[32:35], s94 offen offset:0  lds
    buffer_load_dwordx4 v11, s[32:35], s94 offen offset:1024  lds
    s_add_u32 m0, s99, 6144
    s_add_u32 s94, s100, 229376
    buffer_load_dwordx4 v10, s[32:35], s94 offen offset:0  lds
    buffer_load_dwordx4 v11, s[32:35], s94 offen offset:1024  lds
    s_branch L_p2_join
L_end:
    s_endpgm
.section .rodata,"a"
.p2align 6
.amdhsa_kernel standalone__mixer_channel_mlp__prompt_kernel
  .amdhsa_next_free_vgpr 256
  .amdhsa_next_free_sgpr 102
  .amdhsa_accum_offset 256
  .amdhsa_group_segment_fixed_size 0
  .amdhsa_kernarg_size 64
  .amdhsa_user_sgpr_count 2
  .amdhsa_user_sgpr_kernarg_segment_ptr 1
  .amdhsa_system_sgpr_workgroup_id_x 1
.end_amdhsa_kernel
```
